```python
import torch

def _softmax(x, axis=-1):
    return torch.softmax(x, dim=axis)
def _gelu(x):
    return torch.nn.functional.gelu(x, approximate="tanh")
def _silu(x):
    return torch.nn.functional.silu(x)
def _sigmoid(x):
    return torch.sigmoid(x)
def _layernorm(x, axis=-1, eps=1e-5):
    m = x.mean(dim=axis, keepdim=True)
    v = x.var(dim=axis, keepdim=True, unbiased=False)
    return (x - m) / torch.sqrt(v + eps)
def _scatter_add(tgt, idx, src, axis=0):
    return tgt.clone().index_add_(axis, idx, src)
def _segment_sum(src, seg, n):
    out = torch.zeros((n,) + src.shape[1:], dtype=src.dtype)
    return out.index_add_(0, seg, src)
def _pad(x, pw):
    flat = tuple(v for pair in reversed(pw) for v in pair)
    return torch.nn.functional.pad(x, flat)

kernel_name = 'gated_mix__ssm_conv_s4__linear_attn_block__prompt'

def setup_inputs():

    _w = (lambda a: (lambda t: t.to(torch.bfloat16) if t.is_floating_point() else t)(torch.as_tensor(a)))
    def _A_setup():
        B, L, D, N = 1, 2048, 640, 192
        A_re = -(lambda _x: torch.exp(torch.as_tensor(_x)))((lambda *s: torch.randn(*s, dtype=torch.bfloat16) * 6.4)(D, N))
        A_im = torch.pi * (lambda *s: torch.randn(*s, dtype=torch.bfloat16) * 0.05)(D, N)
        B_re = (lambda *s: torch.randn(*s, dtype=torch.bfloat16) * 0.1)(D, N)
        B_im = (lambda *s: torch.randn(*s, dtype=torch.bfloat16) * 0.1)(D, N)
        C_re = (lambda *s: torch.randn(*s, dtype=torch.bfloat16) * 0.1)(D, N)
        C_im = (lambda *s: torch.randn(*s, dtype=torch.bfloat16) * 0.1)(D, N)
        log_dt = (lambda *s: torch.randn(*s, dtype=torch.bfloat16) * 0.05)(D) * 0.5 - 4.0
        Dskip = (lambda *s: torch.randn(*s, dtype=torch.bfloat16) * 0.05)(D)
        return {
            "u": _w((lambda *s: torch.randn(*s, dtype=torch.bfloat16) * 0.05)(B, L, D)),
            "A_re": _w(A_re),
            "A_im": _w(A_im),
            "B_re": _w(B_re),
            "B_im": _w(B_im),
            "C_re": _w(C_re),
            "C_im": _w(C_im),
            "log_dt": _w(log_dt),
            "Dskip": _w(Dskip),
        }
    _A_in = _A_setup()

    def _B_setup():
        B, S, D = 1, 2048, 640
        return {
            "x": _w((lambda *s: torch.randn(*s, dtype=torch.bfloat16) * 0.05)(B, S, D)),
            "wqkv": _w((lambda *s: torch.randn(*s, dtype=torch.bfloat16) * 0.4)(D, 3 * D)),
            "wo": _w((lambda *s: torch.randn(*s, dtype=torch.bfloat16) * 0.05)(D, D)),
        }
    _B_in = _B_setup()

    return {
        "A_u": _A_in["u"],
        "A_A_re": _A_in["A_re"],
        "A_A_im": _A_in["A_im"],
        "A_B_re": _A_in["B_re"],
        "A_B_im": _A_in["B_im"],
        "A_C_re": _A_in["C_re"],
        "A_C_im": _A_in["C_im"],
        "A_log_dt": _A_in["log_dt"],
        "A_Dskip": _A_in["Dskip"],
        "B_x": _B_in["x"],
        "B_wqkv": _B_in["wqkv"],
        "B_wo": _B_in["wo"],
        "gate_w": _w((lambda *s: torch.randn(*s, dtype=torch.bfloat16) * 0.05)(640) * 16.0),
    }

def reference(A_u, A_A_re, A_A_im, A_B_re, A_B_im, A_C_re, A_C_im, A_log_dt, A_Dskip, B_x, B_wqkv, B_wo, gate_w):
    def _A_ref(u, A_re, A_im, B_re, B_im, C_re, C_im, log_dt, Dskip):
        Bsz, L, D = u.shape
        dt = torch.exp(log_dt)[:, None]
        A = A_re + 1j * A_im
        Bc = B_re + 1j * B_im
        Cc = C_re + 1j * C_im
        logdA = dt * A
        dB = dt * Bc
        l = (lambda x, dt: x.to(dt))(torch.arange(L), A_re.dtype)
        P = torch.exp(logdA[:, :, None] * l[None, None, :])
        K = torch.einsum("dn,dnl,dn->dl", Cc, P, dB).real
        L2 = 2 * L
        Kp = _pad(K, ((0, 0), (0, L)))
        up = (lambda x, *d: x.permute(*d))(u, 0, 2, 1)
        up = _pad(up, ((0, 0), (0, 0), (0, L)))
        Kf = (lambda x, axes=(-2,-1): torch.fft.rfft2(x.float(), dim=axes))(Kp[:, None, :], axes=(-2, -1))
        Uf = (lambda x, axes=(-2,-1): torch.fft.rfft2(x.float(), dim=axes))(up[:, :, None, :], axes=(-2, -1))
        Yf = Uf * Kf[None, :, :, :]
        y = (lambda x, s, axes=(-2,-1): torch.fft.irfft2(x, s=s, dim=axes).to(torch.bfloat16))(Yf, (1, L2), axes=(-2, -1))[:, :, 0, :L]
        y = (lambda x, *d: x.permute(*d))(y, 0, 2, 1) + u * Dskip[None, None, :]
        return y

    def _B_ref(x, wqkv, wo):
        B, S, D = x.shape
        H = 32; Dh = D // H
        qkv = (lambda x, *d: x.permute(*d))((x @ wqkv).reshape(B, S, 3, H, Dh), 2, 0, 3, 1, 4)
        q, k, v = qkv[0], qkv[1], qkv[2]
        phi = lambda t: torch.where(t > 0, t + 1, torch.exp(t)) + 1e-6
        pq, pk = phi(q), phi(k)
        kv = torch.einsum("bhsd,bhse->bhde", pk, v)
        z = torch.einsum("bhsd->bhd", pk)
        num = torch.einsum("bhqd,bhde->bhqe", pq, kv)
        den = torch.einsum("bhqd,bhd->bhq", pq, z)[..., None] + 1e-6
        o = num / den
        return (lambda x, *d: x.permute(*d))(o, 0, 2, 1, 3).reshape(B, S, D) @ wo

    x = A_u
    g = _sigmoid((x * gate_w).sum(-1, keepdims=True))
    a = _A_ref(x, A_A_re, A_A_im, A_B_re, A_B_im, A_C_re, A_C_im, A_log_dt, A_Dskip)
    b = _B_ref(x, B_wqkv, B_wo)
    return g * a + (1 - g) * b
```

```asm
; @launch grid=(256,1,1) block=(512,1,1) lds=163840
.amdgcn_target "amdgcn-amd-amdhsa--gfx950"
.text
.globl gated_mix__ssm_conv_s4__linear_attn_block__prompt_kernel
.p2align 8
.type gated_mix__ssm_conv_s4__linear_attn_block__prompt_kernel,@function
gated_mix__ssm_conv_s4__linear_attn_block__prompt_kernel:
    s_cmp_ge_u32 s2, 256
    s_cbranch_scc1 L_end
    s_load_dwordx16 s[16:31], s[0:1], 0
    s_load_dwordx16 s[32:47], s[0:1], 64
    v_lshrrev_b32 v1, 6, v0
    s_nop 0
    v_readfirstlane_b32 s60, v1
    v_and_b32 v1, 63, v0
    s_cmp_lg_u32 s60, 3
    s_cbranch_scc1 Lpf_1
    s_getpc_b64 s[4:5]
Lpf_1_pc:
    s_lshr_b32 s6, s2, 3
    s_lshl_b32 s6, s6, 7
    v_lshl_add_u32 v2, v1, 12, s6
    v_min_u32 v2, L_code_end-Lpf_1_pc-4, v2
    s_mov_b64 exec, 2047
    global_load_dword v255, v2, s[4:5]
    s_mov_b64 exec, -1
Lpf_1:
    s_bfe_u32 s48, s2, 0x40003
    v_min_u32 v64, 59, v1
    v_mul_u32_u24 v65, 52, v64
    v_lshrrev_b32 v65, 8, v65
    v_mul_u32_u24 v66, 640, v65
    v_lshl_add_u32 v66, v64, 7, v66
    v_lshrrev_b32 v64, 1, v65
    v_mul_u32_u24 v64, 1280, v64
    s_and_b32 s50, s2, 1
    s_mul_i32 s15, s50, 1229440
    s_mul_i32 s13, s48, 23040
    s_add_u32 s13, s13, s15
    s_add_u32 s13, s13, 1280
    v_add3_u32 v37, v66, v64, s13
    s_and_b32 s3, s2, 128
    s_xor_b32 s4, s60, 1
    s_or_b32 s3, s3, s4
    s_cbranch_scc1 L_nt
    v_add_u32 v38, 368640, v37
    s_waitcnt lgkmcnt(0)
    global_load_dword v255, v37, s[36:37]
    global_load_dword v255, v38, s[36:37]
L_nt:
    s_lshr_b32 s3, s2, 3
    s_and_b32 s62, s2, 1
    s_lshl_b32 s62, s62, 2
    s_and_b32 s4, s3, 3
    s_add_u32 s62, s62, s4
    s_cmp_lt_u32 s3, 16
    s_cbranch_scc1 L_g
    s_and_b32 s61, s2, 7
    s_lshl_b32 s61, s61, 4
    s_and_b32 s4, s3, 15
    s_add_u32 s61, s61, s4
    v_mov_b32 v2, 0
    v_mov_b32 v3, 0
    v_mov_b32 v4, 0
    v_mov_b32 v5, 0
    v_mov_b32 v6, 0
    v_mov_b32 v7, 0
    v_mov_b32 v8, 0
    s_mul_i32 s4, s61, 1920
    s_lshl_b32 s5, s60, 8
    s_add_u32 s4, s4, s5
    v_lshl_add_u32 v42, v1, 1, s4
    s_mul_i32 s7, s60, 0xAAAC
    s_lshr_b32 s6, s7, 16
    s_mul_i32 s8, s61, 10
    s_lshl_b32 s9, s6, 1
    s_add_u32 s9, s9, s8
    v_mov_b32 v43, s9
    s_and_b32 s12, s2, 6
    s_lshl_b32 s12, s12, 3
    s_bfe_u32 s13, s2, 0x40003
    s_add_u32 s12, s12, s13
    s_lshl_b32 s12, s12, 6
    s_and_b32 s13, s2, 1
    s_add_u32 s12, s12, s13
    s_mul_i32 s12, s12, 640
    v_lshrrev_b32_e64 v18, 3, v1
    v_mul_u32_u24 v18, 1152, v18
    v_lshl_add_u32 v18, v1, 4, v18
    v_add_u32_e64 v18, s12, v18
    s_waitcnt lgkmcnt(0)
    s_and_b32 s14, s61, 15
    s_xor_b32 s9, s60, 7
    s_or_b32 s14, s14, s9
    s_cbranch_scc1 Ls_nz_2
    s_lshl_b32 s9, s61, 9
    s_add_u32 s9, s9, 131072
    v_lshl_add_u32 v20, v1, 8, s9
    s_mov_b32 exec_hi, 0
    global_store_dwordx4 v20, v[2:5], s[46:47] sc1
    s_mov_b32 exec_hi, -1
    s_lshl_b32 s9, s61, 6
    s_add_u32 s9, s9, 81920
    v_lshl_add_u32 v20, v1, 4, s9
    global_store_dwordx4 v20, v[2:5], s[46:47] sc1
    s_mul_i32 s9, s61, 420
    s_add_u32 s9, s9, 2880
    v_lshl_add_u32 v20, v1, 4, s9
    s_mov_b32 exec_hi, 0x0fffffff
    global_store_dwordx4 v20, v[2:5], s[46:47] offset:-2880 sc1
    global_store_dwordx4 v20, v[2:5], s[46:47] offset:-1920 sc1
    global_store_dwordx4 v20, v[2:5], s[46:47] offset:-960 sc1
    global_store_dwordx4 v20, v[2:5], s[46:47] offset:0 sc1
    global_store_dwordx4 v20, v[2:5], s[46:47] offset:960 sc1
    global_store_dwordx4 v20, v[2:5], s[46:47] offset:1920 sc1
    global_store_dwordx4 v20, v[2:5], s[46:47] offset:2880 sc1
    s_mov_b32 exec_hi, -1
Ls_nz_2:
    global_load_short_d16_hi v8, v43, s[30:31]
    global_load_short_d16_hi v6, v42, s[18:19]
    global_load_short_d16_hi v7, v42, s[20:21]
    global_load_short_d16_hi v2, v42, s[22:23]
    global_load_short_d16_hi v3, v42, s[24:25]
    global_load_short_d16_hi v4, v42, s[26:27]
    global_load_short_d16_hi v5, v42, s[28:29]
    s_mov_b32 s52, s16
    s_mov_b32 s53, s17
    s_mov_b32 s54, 2621440
    s_mov_b32 s55, 0x20000
    v_add_u32 v37, 368640, v37
    s_cmp_lg_u32 s60, 7
    s_cbranch_scc1 Ls_w7_3
    s_setprio 2
    s_mov_b32 s12, 143328
    s_mov_b32 s13, 0
Ls_sl_4:
    s_add_u32 m0, s12, 0
    s_add_u32 s9, s13, 0
    buffer_load_dwordx4 v18, s[52:55], s9 offen lds
    s_add_u32 m0, s12, 1024
    s_add_u32 s9, s13, 10240
    buffer_load_dwordx4 v18, s[52:55], s9 offen lds
    s_add_u32 m0, s12, 2048
    s_add_u32 s9, s13, 20480
    buffer_load_dwordx4 v18, s[52:55], s9 offen lds
    s_add_u32 m0, s12, 3072
    s_add_u32 s9, s13, 30720
    buffer_load_dwordx4 v18, s[52:55], s9 offen lds
    s_add_u32 s12, s12, 4096
    s_add_u32 s13, s13, 128
    s_cmp_lg_u32 s13, 640
    s_cbranch_scc1 Ls_sl_4
Ls_w7_3:
    s_branch L_s
L_g:
    s_and_b32 s61, s2, 6
    s_lshl_b32 s61, s61, 1
    s_lshr_b32 s4, s3, 2
    s_add_u32 s61, s61, s4
    v_and_b32 v4, 15, v1
    v_lshrrev_b32 v5, 4, v1
    s_cmp_ge_u32 s60, 4
    s_cbranch_scc1 Lg_ld_7
    s_cmp_lg_u32 s60, 2
    s_cbranch_scc1 Lg_gw_8
    v_lshlrev_b32_e64 v29, 4, v1
    s_mov_b32 m0, 0
    s_waitcnt lgkmcnt(0)
    s_mov_b32 s52, s40
    s_mov_b32 s53, s41
    s_mov_b32 s54, 1280
    s_mov_b32 s55, 0x20000
    buffer_load_dwordx4 v29, s[52:55], 0 offen lds
    s_mov_b64 exec, 0xffff
    buffer_load_dwordx4 v29, s[52:55], 0 offen offset:1024 lds
    s_mov_b64 exec, -1
Lg_gw_8:
    s_barrier
    s_branch Lg_c_5
Lg_ld_7:
    s_setprio 2
    s_mul_i32 s4, s61, 163840
    s_and_b32 s5, s60, 3
    v_lshrrev_b32 v28, 3, v1
    v_mul_u32_u24 v28, 1280, v28
    s_lshl_b32 s6, s5, 2
    v_add_u32 v29, s6, v5
    v_xor_b32 v29, v29, v1
    v_and_b32 v29, 7, v29
    v_lshl_add_u32 v28, v29, 4, v28
    s_mul_i32 s6, s5, 10240
    s_add_u32 s6, s6, s4
    v_add_u32 v252, s6, v28
    s_mul_i32 s7, s62, 160
    s_lshl_b32 s6, s5, 6
    s_movk_i32 s8, 3840
    v_add_u32 v28, s6, v1
    v_mul_u32_u24 v29, 6554, v28
    v_lshrrev_b32 v29, 16, v29
    v_mul_u32_u24 v30, 10, v29
    v_sub_u32 v28, v28, v30
    v_lshl_add_u32 v28, v28, 4, s7
    v_lshrrev_b32 v30, 1, v29
    v_xor_b32 v30, v30, v29
    v_and_b32 v30, 4, v30
    v_mul_u32_u24 v30, 3, v30
    v_xor_b32_e64 v29, v29, v30
    v_mad_u32_u24 v253, v29, s8, v28
    v_add_u32 v28, 256, v1
    v_mul_u32_u24 v29, 6554, v28
    v_lshrrev_b32 v29, 16, v29
    v_mul_u32_u24 v30, 10, v29
    v_sub_u32 v28, v28, v30
    v_lshl_add_u32 v28, v28, 4, s7
    v_lshrrev_b32 v30, 1, v29
    v_xor_b32 v30, v30, v29
    v_and_b32 v30, 4, v30
    v_mul_u32_u24 v30, 3, v30
    v_xor_b32 v29, v29, v30
    v_mad_u32_u24 v254, v29, s8, v28
    s_and_b32 s7, s5, 1
    s_mul_i32 s7, s7, 122880
    v_add_u32 v254, s7, v254
    s_lshr_b32 s6, s5, 1
    s_lshl_b32 s14, s5, 10
    s_mul_i32 s15, s5, 5120
    s_lshl_b32 s7, s6, 4
    s_add_u32 s15, s15, s7
    s_mul_i32 s58, s6, 1280
    s_and_b32 s56, s2, 1
    s_mul_i32 s57, s56, 1228800
    s_mul_i32 s56, s56, 640
    s_waitcnt lgkmcnt(0)
    s_mov_b32 s48, s16
    s_mov_b32 s49, s17
    s_mov_b32 s50, 2621440
    s_mov_b32 s51, 0x20000
    s_mov_b32 s52, s36
    s_mov_b32 s53, s37
    s_mov_b32 s54, 2457600
    s_mov_b32 s55, 0x20000
    s_barrier
    s_add_u32 m0, s14, 1280
    s_add_u32 s9, s56, 0
    buffer_load_dwordx4 v252, s[48:51], s9 offen lds
    s_add_u32 m0, s14, 17664
    s_add_u32 s9, s57, 1280
    buffer_load_dwordx4 v253, s[52:55], s9 offen lds
    s_add_u32 m0, s14, 5376
    s_add_u32 s9, s56, 40960
    buffer_load_dwordx4 v252, s[48:51], s9 offen lds
    s_add_u32 m0, s14, 22784
    s_add_u32 s9, s57, 124160
    buffer_load_dwordx4 v253, s[52:55], s9 offen lds
    s_add_u32 m0, s15, 21760
    s_add_u32 s9, s57, s58
    s_add_u32 s9, s9, 1280
    buffer_load_dwordx4 v254, s[52:55], s9 offen lds
    s_add_u32 m0, s14, 9472
    s_add_u32 s9, s56, 81920
    buffer_load_dwordx4 v252, s[48:51], s9 offen lds
    s_add_u32 m0, s14, 27920
    s_add_u32 s9, s57, 2560
    buffer_load_dwordx4 v253, s[52:55], s9 offen lds
    s_add_u32 m0, s14, 13568
    s_add_u32 s9, s56, 122880
    buffer_load_dwordx4 v252, s[48:51], s9 offen lds
    s_add_u32 m0, s14, 33040
    s_add_u32 s9, s57, 125440
    buffer_load_dwordx4 v253, s[52:55], s9 offen lds
    s_add_u32 m0, s14, 38176
    s_add_u32 s9, s56, 128
    buffer_load_dwordx4 v252, s[48:51], s9 offen lds
    s_add_u32 m0, s14, 54560
    s_add_u32 s9, s57, 247040
    buffer_load_dwordx4 v253, s[52:55], s9 offen lds
    s_add_u32 m0, s14, 42272
    s_add_u32 s9, s56, 41088
    buffer_load_dwordx4 v252, s[48:51], s9 offen lds
    s_add_u32 m0, s14, 59680
    s_add_u32 s9, s57, 369920
    buffer_load_dwordx4 v253, s[52:55], s9 offen lds
    s_add_u32 m0, s15, 58656
    s_add_u32 s9, s57, s58
    s_add_u32 s9, s9, 247040
    buffer_load_dwordx4 v254, s[52:55], s9 offen lds
    s_add_u32 m0, s14, 46368
    s_add_u32 s9, s56, 82048
    buffer_load_dwordx4 v252, s[48:51], s9 offen lds
    s_mov_b32 s12, s57
    s_sub_u32 s13, 1228800, s57
    s_and_b32 s7, s5, 1
    s_mul_i32 s59, s7, 5120
    s_mul_i32 s7, s6, 10240
    s_sub_u32 s59, s59, s7
    v_lshrrev_b32 v2, 1, v4
    v_xor_b32 v2, v2, v5
    v_lshlrev_b32 v2, 4, v2
    v_lshl_add_u32 v2, v4, 7, v2
    s_lshl_b32 s7, s5, 12
    s_add_u32 s7, s7, 1280
    v_add_u32 v2, s7, v2
    v_xor_b32_e64 v3, 64, v2
    v_add_u32 v6, 73792, v2
    v_add_u32 v7, 73792, v3
    v_lshrrev_b32 v88, 1, v5
    v_lshlrev_b32 v88, 4, v88
    v_and_b32 v28, 1, v5
    v_lshl_add_u32 v88, v28, 2, v88
    v_lshrrev_b32 v28, 2, v4
    v_add_u32 v88, v88, v28
    v_mul_u32_u24 v88, 160, v88
    v_and_b32 v28, 3, v4
    v_lshl_add_u32 v88, v28, 3, v88
    v_add_u32 v88, 112608, v88
    v_lshl_add_u32 v89, v28, 5, v88
    s_add_u32 s7, s56, 0
    v_lshl_add_u32 v90, v5, 4, s7
    s_lshl_b32 s7, s5, 7
    s_add_u32 s7, s7, 45056
    v_and_b32 v28, 31, v1
    v_lshl_add_u32 v91, v28, 2, s7
    s_and_b32 s4, s62, 3
    v_mov_b32 v72, 0
    v_mov_b32 v73, 0
    v_mov_b32 v74, 0
    v_mov_b32 v75, 0
    v_mov_b32 v76, 0
    v_mov_b32 v77, 0
    v_mov_b32 v78, 0
    v_mov_b32 v79, 0
    v_mov_b32 v32, 1.0
    v_mov_b32 v33, 1.0
    v_mov_b32 v34, 1.0
    v_mov_b32 v35, 1.0
    v_mov_b32 v36, 1.0
    v_mov_b32 v37, 1.0
    v_mov_b32 v38, 1.0
    v_mov_b32 v39, 1.0
    v_mov_b32 v40, 1.0
    v_mov_b32 v41, 1.0
    v_mov_b32 v42, 1.0
    v_mov_b32 v43, 1.0
    v_mov_b32 v44, 1.0
    v_mov_b32 v45, 1.0
    v_mov_b32 v46, 1.0
    v_mov_b32 v47, 1.0
    v_mov_b32 v48, 1.0
    v_mov_b32 v49, 1.0
    v_mov_b32 v50, 1.0
    v_mov_b32 v51, 1.0
    v_mov_b32 v52, 1.0
    v_mov_b32 v53, 1.0
    v_mov_b32 v54, 1.0
    v_mov_b32 v55, 1.0
    v_mov_b32 v56, 1.0
    v_mov_b32 v57, 1.0
    v_mov_b32 v58, 1.0
    v_mov_b32 v59, 1.0
    v_mov_b32 v60, 1.0
    v_mov_b32 v61, 1.0
    v_mov_b32 v62, 1.0
    v_mov_b32 v63, 1.0
    v_mov_b32 v64, 1.0
    v_mov_b32 v65, 1.0
    v_mov_b32 v66, 1.0
    v_mov_b32 v67, 1.0
    v_mov_b32 v68, 1.0
    v_mov_b32 v69, 1.0
    v_mov_b32 v70, 1.0
    v_mov_b32 v71, 1.0
    s_waitcnt vmcnt(6)
    s_barrier
    ds_read_b128 v[92:95], v2 offset:0
    ds_read_b128 v[96:99], v2 offset:2048
    ds_read_b128 v[100:103], v3 offset:0
    ds_read_b128 v[104:107], v3 offset:2048
    ds_read_b128 v[80:83], v90 offset:0
    ds_read_b128 v[84:87], v90 offset:64
    s_add_u32 m0, s14, 64816
    s_add_u32 s9, s57, 248320
    buffer_load_dwordx4 v253, s[52:55], s9 offen lds
    s_add_u32 m0, s14, 50464
    s_add_u32 s9, s56, 123008
    buffer_load_dwordx4 v252, s[48:51], s9 offen lds
    s_add_u32 m0, s14, 69936
    s_add_u32 s9, s57, 371200
    buffer_load_dwordx4 v253, s[52:55], s9 offen lds
    s_add_u32 m0, s14, 75072
    s_add_u32 s9, s56, 256
    buffer_load_dwordx4 v252, s[48:51], s9 offen lds
    s_add_u32 m0, s14, 91456
    s_add_u32 s9, s57, 492800
    buffer_load_dwordx4 v253, s[52:55], s9 offen lds
    s_add_u32 m0, s14, 79168
    s_add_u32 s9, s56, 41216
    buffer_load_dwordx4 v252, s[48:51], s9 offen lds
    s_add_u32 m0, s14, 96576
    s_add_u32 s9, s57, 615680
    buffer_load_dwordx4 v253, s[52:55], s9 offen lds
    s_add_u32 m0, s15, 95552
    s_add_u32 s9, s57, s58
    s_add_u32 s9, s9, 492800
    buffer_load_dwordx4 v254, s[52:55], s9 offen lds
    s_add_u32 m0, s14, 83264
    s_add_u32 s9, s56, 82176
    buffer_load_dwordx4 v252, s[48:51], s9 offen lds
    s_waitcnt lgkmcnt(0)
    s_cmp_lg_u32 s4, 0
    s_cbranch_scc1 Lg_g_9
    v_mfma_f32_16x16x32_bf16 v[72:75], v[80:83], v[92:95], v[72:75]
    v_mfma_f32_16x16x32_bf16 v[76:79], v[80:83], v[96:99], v[76:79]
Lg_g_9:
    s_cmp_lg_u32 s4, 1
    s_cbranch_scc1 Lg_g_10
    v_mfma_f32_16x16x32_bf16 v[72:75], v[84:87], v[100:103], v[72:75]
    v_mfma_f32_16x16x32_bf16 v[76:79], v[84:87], v[104:107], v[76:79]
Lg_g_10:
    s_waitcnt vmcnt(6)
    s_barrier
    ds_read_b128 v[108:111], v2 offset:36896
    ds_read_b128 v[112:115], v2 offset:38944
    ds_read_b128 v[116:119], v3 offset:36896
    ds_read_b128 v[120:123], v3 offset:38944
    ds_read_b128 v[80:83], v90 offset:128
    ds_read_b128 v[84:87], v90 offset:192
    s_add_u32 m0, s14, 101712
    s_add_u32 s9, s57, 494080
    buffer_load_dwordx4 v253, s[52:55], s9 offen lds
    s_add_u32 m0, s14, 87360
    s_add_u32 s9, s56, 123136
    buffer_load_dwordx4 v252, s[48:51], s9 offen lds
    s_add_u32 m0, s14, 106832
    s_add_u32 s9, s57, 616960
    buffer_load_dwordx4 v253, s[52:55], s9 offen lds
    s_add_u32 m0, s14, 1280
    s_add_u32 s9, s56, 384
    buffer_load_dwordx4 v252, s[48:51], s9 offen lds
    s_add_u32 m0, s14, 17664
    s_add_u32 s9, s57, 738560
    buffer_load_dwordx4 v253, s[52:55], s9 offen lds
    s_add_u32 m0, s14, 5376
    s_add_u32 s9, s56, 41344
    buffer_load_dwordx4 v252, s[48:51], s9 offen lds
    s_add_u32 m0, s14, 22784
    s_add_u32 s9, s57, 861440
    buffer_load_dwordx4 v253, s[52:55], s9 offen lds
    s_add_u32 m0, s15, 21760
    s_add_u32 s9, s57, s58
    s_add_u32 s9, s9, 738560
    buffer_load_dwordx4 v254, s[52:55], s9 offen lds
    s_add_u32 m0, s14, 9472
    s_add_u32 s9, s56, 82304
    buffer_load_dwordx4 v252, s[48:51], s9 offen lds
    s_waitcnt lgkmcnt(0)
    s_cmp_lg_u32 s4, 2
    s_cbranch_scc1 Lg_g_11
    v_mfma_f32_16x16x32_bf16 v[72:75], v[80:83], v[108:111], v[72:75]
    v_mfma_f32_16x16x32_bf16 v[76:79], v[80:83], v[112:115], v[76:79]
Lg_g_11:
    s_cmp_lg_u32 s4, 3
    s_cbranch_scc1 Lg_g_12
    v_mfma_f32_16x16x32_bf16 v[72:75], v[84:87], v[116:119], v[72:75]
    v_mfma_f32_16x16x32_bf16 v[76:79], v[84:87], v[120:123], v[76:79]
Lg_g_12:
    s_waitcnt vmcnt(6)
    s_barrier
    ds_read_b128 v[124:127], v6 offset:0
    ds_read_b128 v[128:131], v6 offset:2048
    ds_read_b128 v[132:135], v7 offset:0
    ds_read_b128 v[136:139], v7 offset:2048
    ds_read_b128 v[80:83], v90 offset:256
    ds_read_b128 v[84:87], v90 offset:320
    s_add_u32 m0, s14, 27920
    s_add_u32 s9, s57, 739840
    buffer_load_dwordx4 v253, s[52:55], s9 offen lds
    s_add_u32 m0, s14, 13568
    s_add_u32 s9, s56, 123264
    buffer_load_dwordx4 v252, s[48:51], s9 offen lds
    s_add_u32 m0, s14, 33040
    s_add_u32 s9, s57, 862720
    buffer_load_dwordx4 v253, s[52:55], s9 offen lds
    s_add_u32 m0, s14, 38176
    s_add_u32 s9, s56, 512
    buffer_load_dwordx4 v252, s[48:51], s9 offen lds
    s_add_u32 m0, s14, 54560
    s_add_u32 s9, s57, 984320
    buffer_load_dwordx4 v253, s[52:55], s9 offen lds
    s_add_u32 m0, s14, 42272
    s_add_u32 s9, s56, 41472
    buffer_load_dwordx4 v252, s[48:51], s9 offen lds
    s_add_u32 m0, s14, 59680
    s_add_u32 s9, s57, 1107200
    buffer_load_dwordx4 v253, s[52:55], s9 offen lds
    s_add_u32 m0, s15, 58656
    s_add_u32 s9, s57, s58
    s_add_u32 s9, s9, 984320
    buffer_load_dwordx4 v254, s[52:55], s9 offen lds
    s_add_u32 m0, s14, 46368
    s_add_u32 s9, s56, 82432
    buffer_load_dwordx4 v252, s[48:51], s9 offen lds
    s_waitcnt lgkmcnt(0)
    s_cmp_lg_u32 s4, 0
    s_cbranch_scc1 Lg_g_13
    v_mfma_f32_16x16x32_bf16 v[72:75], v[80:83], v[124:127], v[72:75]
    v_mfma_f32_16x16x32_bf16 v[76:79], v[80:83], v[128:131], v[76:79]
Lg_g_13:
    s_cmp_lg_u32 s4, 1
    s_cbranch_scc1 Lg_g_14
    v_mfma_f32_16x16x32_bf16 v[72:75], v[84:87], v[132:135], v[72:75]
    v_mfma_f32_16x16x32_bf16 v[76:79], v[84:87], v[136:139], v[76:79]
Lg_g_14:
    s_waitcnt vmcnt(6)
    s_barrier
    ds_read_b128 v[140:143], v2 offset:0
    ds_read_b128 v[144:147], v2 offset:2048
    ds_read_b128 v[148:151], v3 offset:0
    ds_read_b128 v[152:155], v3 offset:2048
    ds_read_b128 v[80:83], v90 offset:384
    ds_read_b128 v[84:87], v90 offset:448
    s_add_u32 m0, s14, 64816
    s_add_u32 s9, s57, 985600
    buffer_load_dwordx4 v253, s[52:55], s9 offen lds
    s_add_u32 m0, s14, 50464
    s_add_u32 s9, s56, 123392
    buffer_load_dwordx4 v252, s[48:51], s9 offen lds
    s_add_u32 m0, s14, 69936
    s_add_u32 s9, s57, 1108480
    buffer_load_dwordx4 v253, s[52:55], s9 offen lds
    s_sub_u32 s56, 640, s56
    s_sub_u32 s57, 1228800, s57
    s_add_u32 m0, s14, 75072
    s_add_u32 s9, s56, 0
    buffer_load_dwordx4 v252, s[48:51], s9 offen lds
    s_add_u32 m0, s14, 91456
    s_add_u32 s9, s57, 1280
    buffer_load_dwordx4 v253, s[52:55], s9 offen lds
    s_add_u32 m0, s14, 79168
    s_add_u32 s9, s56, 40960
    buffer_load_dwordx4 v252, s[48:51], s9 offen lds
    s_add_u32 m0, s14, 96576
    s_add_u32 s9, s57, 124160
    buffer_load_dwordx4 v253, s[52:55], s9 offen lds
    s_add_u32 m0, s15, 95552
    s_add_u32 s9, s57, s58
    s_add_u32 s9, s9, 1280
    buffer_load_dwordx4 v254, s[52:55], s9 offen lds
    s_add_u32 m0, s14, 83264
    s_add_u32 s9, s56, 81920
    buffer_load_dwordx4 v252, s[48:51], s9 offen lds
    s_waitcnt lgkmcnt(0)
    s_cmp_lg_u32 s4, 2
    s_cbranch_scc1 Lg_g_15
    v_mfma_f32_16x16x32_bf16 v[72:75], v[80:83], v[140:143], v[72:75]
    v_mfma_f32_16x16x32_bf16 v[76:79], v[80:83], v[144:147], v[76:79]
Lg_g_15:
    s_cmp_lg_u32 s4, 3
    s_cbranch_scc1 Lg_g_16
    v_mfma_f32_16x16x32_bf16 v[72:75], v[84:87], v[148:151], v[72:75]
    v_mfma_f32_16x16x32_bf16 v[76:79], v[84:87], v[152:155], v[76:79]
Lg_g_16:
    s_waitcnt vmcnt(6)
    s_barrier
    ds_read_b128 v[156:159], v2 offset:36896
    ds_read_b128 v[160:163], v2 offset:38944
    ds_read_b128 v[164:167], v3 offset:36896
    ds_read_b128 v[168:171], v3 offset:38944
    ds_read_b128 v[80:83], v90 offset:512
    ds_read_b128 v[84:87], v90 offset:576
    s_add_u32 m0, s14, 101712
    s_add_u32 s9, s57, 2560
    buffer_load_dwordx4 v253, s[52:55], s9 offen lds
    s_add_u32 m0, s14, 87360
    s_add_u32 s9, s56, 122880
    buffer_load_dwordx4 v252, s[48:51], s9 offen lds
    s_add_u32 m0, s14, 106832
    s_add_u32 s9, s57, 125440
    buffer_load_dwordx4 v253, s[52:55], s9 offen lds
    s_add_u32 m0, s14, 1280
    s_add_u32 s9, s56, 128
    buffer_load_dwordx4 v252, s[48:51], s9 offen lds
    s_add_u32 m0, s14, 17664
    s_add_u32 s9, s57, 247040
    buffer_load_dwordx4 v253, s[52:55], s9 offen lds
    s_add_u32 m0, s14, 5376
    s_add_u32 s9, s56, 41088
    buffer_load_dwordx4 v252, s[48:51], s9 offen lds
    s_add_u32 m0, s14, 22784
    s_add_u32 s9, s57, 369920
    buffer_load_dwordx4 v253, s[52:55], s9 offen lds
    s_add_u32 m0, s15, 21760
    s_add_u32 s9, s57, s58
    s_add_u32 s9, s9, 247040
    buffer_load_dwordx4 v254, s[52:55], s9 offen lds
    s_add_u32 m0, s14, 9472
    s_add_u32 s9, s56, 82048
    buffer_load_dwordx4 v252, s[48:51], s9 offen lds
    s_waitcnt lgkmcnt(0)
    s_cmp_lg_u32 s4, 0
    s_cbranch_scc1 Lg_g_17
    v_mfma_f32_16x16x32_bf16 v[72:75], v[80:83], v[156:159], v[72:75]
    v_mfma_f32_16x16x32_bf16 v[76:79], v[80:83], v[160:163], v[76:79]
Lg_g_17:
    s_cmp_lg_u32 s4, 1
    s_cbranch_scc1 Lg_g_18
    v_mfma_f32_16x16x32_bf16 v[72:75], v[84:87], v[164:167], v[72:75]
    v_mfma_f32_16x16x32_bf16 v[76:79], v[84:87], v[168:171], v[76:79]
Lg_g_18:
    s_waitcnt vmcnt(6)
    s_barrier
    ds_read_b128 v[172:175], v6 offset:0
    ds_read_b128 v[176:179], v6 offset:2048
    ds_read_b128 v[180:183], v7 offset:0
    ds_read_b128 v[184:187], v7 offset:2048
    s_add_u32 m0, s14, 27920
    s_add_u32 s9, s57, 248320
    buffer_load_dwordx4 v253, s[52:55], s9 offen lds
    s_add_u32 m0, s14, 13568
    s_add_u32 s9, s56, 123008
    buffer_load_dwordx4 v252, s[48:51], s9 offen lds
    s_add_u32 m0, s14, 33040
    s_add_u32 s9, s57, 371200
    buffer_load_dwordx4 v253, s[52:55], s9 offen lds
    s_add_u32 m0, s14, 38176
    s_add_u32 s9, s56, 256
    buffer_load_dwordx4 v252, s[48:51], s9 offen lds
    s_add_u32 m0, s14, 54560
    s_add_u32 s9, s57, 492800
    buffer_load_dwordx4 v253, s[52:55], s9 offen lds
    s_add_u32 m0, s14, 42272
    s_add_u32 s9, s56, 41216
    buffer_load_dwordx4 v252, s[48:51], s9 offen lds
    s_add_u32 m0, s14, 59680
    s_add_u32 s9, s57, 615680
    buffer_load_dwordx4 v253, s[52:55], s9 offen lds
    s_add_u32 m0, s15, 58656
    s_add_u32 s9, s57, s58
    s_add_u32 s9, s9, 492800
    buffer_load_dwordx4 v254, s[52:55], s9 offen lds
    s_add_u32 m0, s14, 46368
    s_add_u32 s9, s56, 82176
    buffer_load_dwordx4 v252, s[48:51], s9 offen lds
    s_waitcnt lgkmcnt(0)
    s_waitcnt vmcnt(6)
    s_barrier
    ds_read_b128 v[188:191], v2 offset:0
    ds_read_b128 v[192:195], v2 offset:2048
    ds_read_b128 v[196:199], v3 offset:0
    ds_read_b128 v[200:203], v3 offset:2048
    s_add_u32 m0, s14, 64816
    s_add_u32 s9, s57, 494080
    buffer_load_dwordx4 v253, s[52:55], s9 offen lds
    s_add_u32 m0, s14, 50464
    s_add_u32 s9, s56, 123136
    buffer_load_dwordx4 v252, s[48:51], s9 offen lds
    s_add_u32 m0, s14, 69936
    s_add_u32 s9, s57, 616960
    buffer_load_dwordx4 v253, s[52:55], s9 offen lds
    s_add_u32 m0, s14, 75072
    s_add_u32 s9, s56, 384
    buffer_load_dwordx4 v252, s[48:51], s9 offen lds
    s_add_u32 m0, s14, 91456
    s_add_u32 s9, s57, 738560
    buffer_load_dwordx4 v253, s[52:55], s9 offen lds
    s_add_u32 m0, s14, 79168
    s_add_u32 s9, s56, 41344
    buffer_load_dwordx4 v252, s[48:51], s9 offen lds
    s_add_u32 m0, s14, 96576
    s_add_u32 s9, s57, 861440
    buffer_load_dwordx4 v253, s[52:55], s9 offen lds
    s_add_u32 m0, s15, 95552
    s_add_u32 s9, s57, s58
    s_add_u32 s9, s9, 738560
    buffer_load_dwordx4 v254, s[52:55], s9 offen lds
    s_add_u32 m0, s14, 83264
    s_add_u32 s9, s56, 82304
    buffer_load_dwordx4 v252, s[48:51], s9 offen lds
    s_waitcnt lgkmcnt(0)
    s_waitcnt vmcnt(6)
    s_barrier
    ds_read_b128 v[204:207], v2 offset:36896
    ds_read_b128 v[208:211], v2 offset:38944
    ds_read_b128 v[212:215], v3 offset:36896
    ds_read_b128 v[216:219], v3 offset:38944
    s_add_u32 m0, s14, 101712
    s_add_u32 s9, s57, 739840
    buffer_load_dwordx4 v253, s[52:55], s9 offen lds
    s_add_u32 m0, s14, 87360
    s_add_u32 s9, s56, 123264
    buffer_load_dwordx4 v252, s[48:51], s9 offen lds
    s_add_u32 m0, s14, 106832
    s_add_u32 s9, s57, 862720
    buffer_load_dwordx4 v253, s[52:55], s9 offen lds
    s_add_u32 m0, s14, 1280
    s_add_u32 s9, s56, 512
    buffer_load_dwordx4 v252, s[48:51], s9 offen lds
    s_add_u32 m0, s14, 17664
    s_add_u32 s9, s57, 984320
    buffer_load_dwordx4 v253, s[52:55], s9 offen lds
    s_add_u32 m0, s14, 5376
    s_add_u32 s9, s56, 41472
    buffer_load_dwordx4 v252, s[48:51], s9 offen lds
    s_add_u32 m0, s14, 22784
    s_add_u32 s9, s57, 1107200
    buffer_load_dwordx4 v253, s[52:55], s9 offen lds
    s_add_u32 m0, s15, 21760
    s_add_u32 s9, s57, s58
    s_add_u32 s9, s9, 984320
    buffer_load_dwordx4 v254, s[52:55], s9 offen lds
    s_add_u32 m0, s14, 9472
    s_add_u32 s9, s56, 82432
    buffer_load_dwordx4 v252, s[48:51], s9 offen lds
    s_waitcnt lgkmcnt(0)
    s_waitcnt vmcnt(6)
    s_barrier
    ds_read_b128 v[220:223], v6 offset:0
    ds_read_b128 v[224:227], v6 offset:2048
    ds_read_b128 v[228:231], v7 offset:0
    ds_read_b128 v[232:235], v7 offset:2048
    s_add_u32 m0, s14, 27920
    s_add_u32 s9, s57, 985600
    buffer_load_dwordx4 v253, s[52:55], s9 offen lds
    s_add_u32 m0, s14, 13568
    s_add_u32 s9, s56, 123392
    buffer_load_dwordx4 v252, s[48:51], s9 offen lds
    s_add_u32 m0, s14, 33040
    s_add_u32 s9, s57, 1108480
    buffer_load_dwordx4 v253, s[52:55], s9 offen lds
    s_add_u32 m0, s14, 153568
    s_add_u32 s9, s12, 0
    buffer_load_dwordx4 v253, s[52:55], s9 offen lds
    s_add_u32 m0, s14, 158688
    s_add_u32 s9, s12, 122880
    buffer_load_dwordx4 v253, s[52:55], s9 offen lds
    s_add_u32 s9, s12, 0
    s_add_u32 s8, s12, 245760
    s_cmp_eq_u32 s6, 0
    s_cselect_b32 s9, s9, s8
    s_add_u32 m0, s59, 157664
    s_nop 0
    buffer_load_dwordx4 v254, s[52:55], s9 offen lds
    s_add_u32 m0, s14, 143328
    s_add_u32 s9, s12, 245760
    buffer_load_dwordx4 v253, s[52:55], s9 offen lds
    s_add_u32 m0, s14, 148448
    s_add_u32 s9, s12, 368640
    buffer_load_dwordx4 v253, s[52:55], s9 offen lds
    s_waitcnt lgkmcnt(0)
    s_waitcnt vmcnt(5)
    s_barrier
    ds_read_b128 v[236:239], v2 offset:0
    ds_read_b128 v[240:243], v2 offset:2048
    ds_read_b128 v[244:247], v3 offset:0
    ds_read_b128 v[248:251], v3 offset:2048
    s_add_u32 m0, s14, 133088
    s_add_u32 s9, s12, 491520
    buffer_load_dwordx4 v253, s[52:55], s9 offen lds
    s_add_u32 m0, s14, 138208
    s_add_u32 s9, s12, 614400
    buffer_load_dwordx4 v253, s[52:55], s9 offen lds
    s_add_u32 s9, s12, 491520
    s_add_u32 s8, s12, 737280
    s_cmp_eq_u32 s6, 0
    s_cselect_b32 s9, s9, s8
    s_add_u32 m0, s59, 137184
    s_nop 0
    buffer_load_dwordx4 v254, s[52:55], s9 offen lds
    s_add_u32 m0, s14, 122848
    s_add_u32 s9, s12, 737280
    buffer_load_dwordx4 v253, s[52:55], s9 offen lds
    s_add_u32 m0, s14, 127968
    s_add_u32 s9, s12, 860160
    buffer_load_dwordx4 v253, s[52:55], s9 offen lds
    s_mov_b32 s10, 0xffff0000
    s_mov_b32 s11, 0xffff0000
    v_cndmask_b32 v72, v72, v76, s[10:11]
    ds_write_b32 v91, v72
    s_waitcnt lgkmcnt(0)
    s_waitcnt vmcnt(5)
    s_barrier
    ds_read_b64_tr_b16 v[4:5], v88 offset:40960
    ds_read_b64_tr_b16 v[6:7], v88 offset:42240
    ds_read_b64_tr_b16 v[8:9], v88 offset:41000
    ds_read_b64_tr_b16 v[10:11], v88 offset:42280
    ds_read_b64_tr_b16 v[12:13], v88 offset:41040
    ds_read_b64_tr_b16 v[14:15], v88 offset:42320
    ds_read_b64_tr_b16 v[16:17], v88 offset:41080
    ds_read_b64_tr_b16 v[18:19], v88 offset:42360
    ds_read_b64_tr_b16 v[20:21], v89 offset:40992
    ds_read_b64_tr_b16 v[22:23], v89 offset:42272
    ds_read_b64_tr_b16 v[24:25], v88 offset:46080
    ds_read_b64_tr_b16 v[26:27], v88 offset:47360
    s_waitcnt lgkmcnt(8)
    v_mfma_f32_16x16x32_bf16 v[32:35], v[4:7], v[92:95], v[32:35]
    ds_read_b64_tr_b16 v[28:29], v88 offset:46120
    v_mfma_f32_16x16x32_bf16 v[36:39], v[4:7], v[96:99], v[36:39]
    ds_read_b64_tr_b16 v[30:31], v88 offset:47400
    s_add_u32 m0, s14, 112608
    s_add_u32 s9, s12, 983040
    buffer_load_dwordx4 v253, s[52:55], s9 offen lds
    v_mfma_f32_16x16x32_bf16 v[40:43], v[8:11], v[92:95], v[40:43]
    ds_read_b64_tr_b16 v[4:5], v88 offset:46160
    v_mfma_f32_16x16x32_bf16 v[44:47], v[8:11], v[96:99], v[44:47]
    ds_read_b64_tr_b16 v[6:7], v88 offset:47440
    s_add_u32 m0, s14, 117728
    s_add_u32 s9, s12, 1105920
    buffer_load_dwordx4 v253, s[52:55], s9 offen lds
    s_waitcnt lgkmcnt(8)
    v_mfma_f32_16x16x32_bf16 v[48:51], v[12:15], v[92:95], v[48:51]
    ds_read_b64_tr_b16 v[8:9], v88 offset:46200
    v_mfma_f32_16x16x32_bf16 v[52:55], v[12:15], v[96:99], v[52:55]
    ds_read_b64_tr_b16 v[10:11], v88 offset:47480
    s_add_u32 s9, s12, 983040
    s_add_u32 s8, s13, 0
    s_cmp_eq_u32 s6, 0
    s_cselect_b32 s9, s9, s8
    s_add_u32 m0, s59, 116704
    s_nop 0
    buffer_load_dwordx4 v254, s[52:55], s9 offen lds
    v_mfma_f32_16x16x32_bf16 v[56:59], v[16:19], v[92:95], v[56:59]
    ds_read_b64_tr_b16 v[12:13], v89 offset:46112
    v_mfma_f32_16x16x32_bf16 v[60:63], v[16:19], v[96:99], v[60:63]
    ds_read_b64_tr_b16 v[14:15], v89 offset:47392
    s_add_u32 m0, s14, 102368
    s_add_u32 s9, s13, 0
    buffer_load_dwordx4 v253, s[52:55], s9 offen lds
    s_waitcnt lgkmcnt(8)
    v_mfma_f32_16x16x32_bf16 v[64:67], v[20:23], v[92:95], v[64:67]
    ds_read_b64_tr_b16 v[16:17], v88 offset:30720
    v_mfma_f32_16x16x32_bf16 v[68:71], v[20:23], v[96:99], v[68:71]
    ds_read_b64_tr_b16 v[18:19], v88 offset:32000
    s_add_u32 m0, s14, 107488
    s_add_u32 s9, s13, 122880
    buffer_load_dwordx4 v253, s[52:55], s9 offen lds
    v_mfma_f32_16x16x32_bf16 v[32:35], v[24:27], v[100:103], v[32:35]
    ds_read_b64_tr_b16 v[20:21], v88 offset:30760
    v_mfma_f32_16x16x32_bf16 v[36:39], v[24:27], v[104:107], v[36:39]
    ds_read_b64_tr_b16 v[22:23], v88 offset:32040
    s_add_u32 m0, s14, 92128
    s_add_u32 s9, s13, 245760
    buffer_load_dwordx4 v253, s[52:55], s9 offen lds
    s_waitcnt lgkmcnt(8)
    v_mfma_f32_16x16x32_bf16 v[40:43], v[28:31], v[100:103], v[40:43]
    ds_read_b64_tr_b16 v[24:25], v88 offset:30800
    v_mfma_f32_16x16x32_bf16 v[44:47], v[28:31], v[104:107], v[44:47]
    ds_read_b64_tr_b16 v[26:27], v88 offset:32080
    s_add_u32 m0, s14, 97248
    s_add_u32 s9, s13, 368640
    buffer_load_dwordx4 v253, s[52:55], s9 offen lds
    v_mfma_f32_16x16x32_bf16 v[48:51], v[4:7], v[100:103], v[48:51]
    ds_read_b64_tr_b16 v[28:29], v88 offset:30840
    v_mfma_f32_16x16x32_bf16 v[52:55], v[4:7], v[104:107], v[52:55]
    ds_read_b64_tr_b16 v[30:31], v88 offset:32120
    s_add_u32 s9, s13, 245760
    s_add_u32 s8, s13, 491520
    s_cmp_eq_u32 s6, 0
    s_cselect_b32 s9, s9, s8
    s_add_u32 m0, s59, 96224
    s_nop 0
    buffer_load_dwordx4 v254, s[52:55], s9 offen lds
    s_waitcnt lgkmcnt(8)
    v_mfma_f32_16x16x32_bf16 v[56:59], v[8:11], v[100:103], v[56:59]
    ds_read_b64_tr_b16 v[4:5], v89 offset:30752
    v_mfma_f32_16x16x32_bf16 v[60:63], v[8:11], v[104:107], v[60:63]
    ds_read_b64_tr_b16 v[6:7], v89 offset:32032
    s_add_u32 m0, s14, 81888
    s_add_u32 s9, s13, 491520
    buffer_load_dwordx4 v253, s[52:55], s9 offen lds
    v_mfma_f32_16x16x32_bf16 v[64:67], v[12:15], v[100:103], v[64:67]
    ds_read_b64_tr_b16 v[8:9], v88 offset:35840
    v_mfma_f32_16x16x32_bf16 v[68:71], v[12:15], v[104:107], v[68:71]
    ds_read_b64_tr_b16 v[10:11], v88 offset:37120
    s_add_u32 m0, s14, 87008
    s_add_u32 s9, s13, 614400
    buffer_load_dwordx4 v253, s[52:55], s9 offen lds
    s_waitcnt lgkmcnt(8)
    v_mfma_f32_16x16x32_bf16 v[32:35], v[16:19], v[108:111], v[32:35]
    ds_read_b64_tr_b16 v[12:13], v88 offset:35880
    v_mfma_f32_16x16x32_bf16 v[36:39], v[16:19], v[112:115], v[36:39]
    ds_read_b64_tr_b16 v[14:15], v88 offset:37160
    s_add_u32 m0, s14, 71648
    s_add_u32 s9, s13, 737280
    buffer_load_dwordx4 v253, s[52:55], s9 offen lds
    v_mfma_f32_16x16x32_bf16 v[40:43], v[20:23], v[108:111], v[40:43]
    ds_read_b64_tr_b16 v[16:17], v88 offset:35920
    v_mfma_f32_16x16x32_bf16 v[44:47], v[20:23], v[112:115], v[44:47]
    ds_read_b64_tr_b16 v[18:19], v88 offset:37200
    s_add_u32 m0, s14, 76768
    s_add_u32 s9, s13, 860160
    buffer_load_dwordx4 v253, s[52:55], s9 offen lds
    s_waitcnt lgkmcnt(8)
    v_mfma_f32_16x16x32_bf16 v[48:51], v[24:27], v[108:111], v[48:51]
    ds_read_b64_tr_b16 v[20:21], v88 offset:35960
    v_mfma_f32_16x16x32_bf16 v[52:55], v[24:27], v[112:115], v[52:55]
    ds_read_b64_tr_b16 v[22:23], v88 offset:37240
    s_add_u32 s9, s13, 737280
    s_add_u32 s8, s13, 983040
    s_cmp_eq_u32 s6, 0
    s_cselect_b32 s9, s9, s8
    s_add_u32 m0, s59, 75744
    s_nop 0
    buffer_load_dwordx4 v254, s[52:55], s9 offen lds
    v_mfma_f32_16x16x32_bf16 v[56:59], v[28:31], v[108:111], v[56:59]
    ds_read_b64_tr_b16 v[24:25], v89 offset:35872
    v_mfma_f32_16x16x32_bf16 v[60:63], v[28:31], v[112:115], v[60:63]
    ds_read_b64_tr_b16 v[26:27], v89 offset:37152
    s_add_u32 m0, s14, 61408
    s_add_u32 s9, s13, 983040
    buffer_load_dwordx4 v253, s[52:55], s9 offen lds
    s_add_u32 m0, s14, 66528
    s_add_u32 s9, s13, 1105920
    buffer_load_dwordx4 v253, s[52:55], s9 offen lds
    s_waitcnt vmcnt(0)
    s_barrier
    s_waitcnt lgkmcnt(8)
    v_mfma_f32_16x16x32_bf16 v[64:67], v[4:7], v[108:111], v[64:67]
    ds_read_b64_tr_b16 v[28:29], v88 offset:20480
    v_mov_b32 v80, 0x3fb8aa3b
    v_mfma_f32_16x16x32_bf16 v[68:71], v[4:7], v[112:115], v[68:71]
    ds_read_b64_tr_b16 v[30:31], v88 offset:21760
    v_mov_b32 v81, 0x358637bd
    v_mfma_f32_16x16x32_bf16 v[32:35], v[8:11], v[116:119], v[32:35]
    ds_read_b64_tr_b16 v[4:5], v88 offset:20520
    v_bfe_u32 v84, v1, 3, 2
    v_mfma_f32_16x16x32_bf16 v[36:39], v[8:11], v[120:123], v[36:39]
    ds_read_b64_tr_b16 v[6:7], v88 offset:21800
    v_and_b32 v85, 3, v1
    s_waitcnt lgkmcnt(8)
    v_mfma_f32_16x16x32_bf16 v[40:43], v[12:15], v[116:119], v[40:43]
    ds_read_b64_tr_b16 v[8:9], v88 offset:20560
    v_lshl_add_u32 v84, v84, 2, v85
    v_mfma_f32_16x16x32_bf16 v[44:47], v[12:15], v[120:123], v[44:47]
    ds_read_b64_tr_b16 v[10:11], v88 offset:21840
    v_bfe_u32 v85, v1, 2, 1
    v_mfma_f32_16x16x32_bf16 v[48:51], v[16:19], v[116:119], v[48:51]
    ds_read_b64_tr_b16 v[12:13], v88 offset:20600
    v_lshl_add_u32 v84, v84, 1, v85
    v_mfma_f32_16x16x32_bf16 v[52:55], v[16:19], v[120:123], v[52:55]
    ds_read_b64_tr_b16 v[14:15], v88 offset:21880
    v_min_u32 v84, 20, v84
    s_waitcnt lgkmcnt(8)
    v_mfma_f32_16x16x32_bf16 v[56:59], v[20:23], v[116:119], v[56:59]
    ds_read_b64_tr_b16 v[16:17], v89 offset:20512
    v_mul_u32_u24_e64 v84, 40, v84
    v_mfma_f32_16x16x32_bf16 v[60:63], v[20:23], v[120:123], v[60:63]
    ds_read_b64_tr_b16 v[18:19], v89 offset:21792
    v_lshrrev_b32_e64 v85, 5, v1
    v_mfma_f32_16x16x32_bf16 v[64:67], v[24:27], v[116:119], v[64:67]
    ds_read_b64_tr_b16 v[20:21], v88 offset:25600
    v_lshl_add_u32 v85, v85, 4, v84
    v_mfma_f32_16x16x32_bf16 v[68:71], v[24:27], v[120:123], v[68:71]
    ds_read_b64_tr_b16 v[22:23], v88 offset:26880
    s_waitcnt lgkmcnt(8)
    v_mfma_f32_16x16x32_bf16 v[32:35], v[28:31], v[124:127], v[32:35]
    ds_read_b64_tr_b16 v[24:25], v88 offset:25640
    v_mfma_f32_16x16x32_bf16 v[36:39], v[28:31], v[128:131], v[36:39]
    ds_read_b64_tr_b16 v[26:27], v88 offset:26920
    v_mfma_f32_16x16x32_bf16 v[40:43], v[4:7], v[124:127], v[40:43]
    ds_read_b64_tr_b16 v[28:29], v88 offset:25680
    v_mfma_f32_16x16x32_bf16 v[44:47], v[4:7], v[128:131], v[44:47]
    ds_read_b64_tr_b16 v[30:31], v88 offset:26960
    s_waitcnt lgkmcnt(8)
    v_mfma_f32_16x16x32_bf16 v[48:51], v[8:11], v[124:127], v[48:51]
    ds_read_b64_tr_b16 v[4:5], v88 offset:25720
    v_mfma_f32_16x16x32_bf16 v[52:55], v[8:11], v[128:131], v[52:55]
    ds_read_b64_tr_b16 v[6:7], v88 offset:27000
    v_mfma_f32_16x16x32_bf16 v[56:59], v[12:15], v[124:127], v[56:59]
    ds_read_b64_tr_b16 v[8:9], v89 offset:25632
    v_mfma_f32_16x16x32_bf16 v[60:63], v[12:15], v[128:131], v[60:63]
    ds_read_b64_tr_b16 v[10:11], v89 offset:26912
    s_waitcnt lgkmcnt(8)
    v_mfma_f32_16x16x32_bf16 v[64:67], v[16:19], v[124:127], v[64:67]
    ds_read_b64_tr_b16 v[12:13], v88 offset:10240
    v_mfma_f32_16x16x32_bf16 v[68:71], v[16:19], v[128:131], v[68:71]
    ds_read_b64_tr_b16 v[14:15], v88 offset:11520
    v_mfma_f32_16x16x32_bf16 v[32:35], v[20:23], v[132:135], v[32:35]
    ds_read_b64_tr_b16 v[16:17], v88 offset:10280
    v_mfma_f32_16x16x32_bf16 v[36:39], v[20:23], v[136:139], v[36:39]
    ds_read_b64_tr_b16 v[18:19], v88 offset:11560
    s_waitcnt lgkmcnt(8)
    v_mfma_f32_16x16x32_bf16 v[40:43], v[24:27], v[132:135], v[40:43]
    ds_read_b64_tr_b16 v[20:21], v88 offset:10320
    v_mfma_f32_16x16x32_bf16 v[44:47], v[24:27], v[136:139], v[44:47]
    ds_read_b64_tr_b16 v[22:23], v88 offset:11600
    v_mfma_f32_16x16x32_bf16 v[48:51], v[28:31], v[132:135], v[48:51]
    ds_read_b64_tr_b16 v[24:25], v88 offset:10360
    v_mfma_f32_16x16x32_bf16 v[52:55], v[28:31], v[136:139], v[52:55]
    ds_read_b64_tr_b16 v[26:27], v88 offset:11640
    s_waitcnt lgkmcnt(8)
    v_mfma_f32_16x16x32_bf16 v[56:59], v[4:7], v[132:135], v[56:59]
    ds_read_b64_tr_b16 v[28:29], v89 offset:10272
    v_mfma_f32_16x16x32_bf16 v[60:63], v[4:7], v[136:139], v[60:63]
    ds_read_b64_tr_b16 v[30:31], v89 offset:11552
    v_mfma_f32_16x16x32_bf16 v[64:67], v[8:11], v[132:135], v[64:67]
    ds_read_b64_tr_b16 v[4:5], v88 offset:15360
    v_mfma_f32_16x16x32_bf16 v[68:71], v[8:11], v[136:139], v[68:71]
    ds_read_b64_tr_b16 v[6:7], v88 offset:16640
    s_waitcnt lgkmcnt(8)
    v_mfma_f32_16x16x32_bf16 v[32:35], v[12:15], v[140:143], v[32:35]
    ds_read_b64_tr_b16 v[8:9], v88 offset:15400
    v_mfma_f32_16x16x32_bf16 v[36:39], v[12:15], v[144:147], v[36:39]
    ds_read_b64_tr_b16 v[10:11], v88 offset:16680
    v_mfma_f32_16x16x32_bf16 v[40:43], v[16:19], v[140:143], v[40:43]
    ds_read_b64_tr_b16 v[12:13], v88 offset:15440
    v_mfma_f32_16x16x32_bf16 v[44:47], v[16:19], v[144:147], v[44:47]
    ds_read_b64_tr_b16 v[14:15], v88 offset:16720
    s_waitcnt lgkmcnt(8)
    v_mfma_f32_16x16x32_bf16 v[48:51], v[20:23], v[140:143], v[48:51]
    ds_read_b64_tr_b16 v[16:17], v88 offset:15480
    v_mfma_f32_16x16x32_bf16 v[52:55], v[20:23], v[144:147], v[52:55]
    ds_read_b64_tr_b16 v[18:19], v88 offset:16760
    v_mfma_f32_16x16x32_bf16 v[56:59], v[24:27], v[140:143], v[56:59]
    ds_read_b64_tr_b16 v[20:21], v89 offset:15392
    v_mfma_f32_16x16x32_bf16 v[60:63], v[24:27], v[144:147], v[60:63]
    ds_read_b64_tr_b16 v[22:23], v89 offset:16672
    s_waitcnt lgkmcnt(8)
    v_mfma_f32_16x16x32_bf16 v[64:67], v[28:31], v[140:143], v[64:67]
    ds_read_b64_tr_b16 v[24:25], v88 offset:0
    v_mfma_f32_16x16x32_bf16 v[68:71], v[28:31], v[144:147], v[68:71]
    ds_read_b64_tr_b16 v[26:27], v88 offset:1280
    v_mfma_f32_16x16x32_bf16 v[32:35], v[4:7], v[148:151], v[32:35]
    ds_read_b64_tr_b16 v[28:29], v88 offset:40
    v_mfma_f32_16x16x32_bf16 v[36:39], v[4:7], v[152:155], v[36:39]
    ds_read_b64_tr_b16 v[30:31], v88 offset:1320
    s_waitcnt lgkmcnt(8)
    v_mfma_f32_16x16x32_bf16 v[40:43], v[8:11], v[148:151], v[40:43]
    ds_read_b64_tr_b16 v[4:5], v88 offset:80
    v_mfma_f32_16x16x32_bf16 v[44:47], v[8:11], v[152:155], v[44:47]
    ds_read_b64_tr_b16 v[6:7], v88 offset:1360
    v_mfma_f32_16x16x32_bf16 v[48:51], v[12:15], v[148:151], v[48:51]
    ds_read_b64_tr_b16 v[8:9], v88 offset:120
    v_mfma_f32_16x16x32_bf16 v[52:55], v[12:15], v[152:155], v[52:55]
    ds_read_b64_tr_b16 v[10:11], v88 offset:1400
    s_waitcnt lgkmcnt(8)
    v_mfma_f32_16x16x32_bf16 v[56:59], v[16:19], v[148:151], v[56:59]
    ds_read_b64_tr_b16 v[12:13], v89 offset:32
    v_mfma_f32_16x16x32_bf16 v[60:63], v[16:19], v[152:155], v[60:63]
    ds_read_b64_tr_b16 v[14:15], v89 offset:1312
    v_mfma_f32_16x16x32_bf16 v[64:67], v[20:23], v[148:151], v[64:67]
    ds_read_b64_tr_b16 v[16:17], v88 offset:5120
    v_mfma_f32_16x16x32_bf16 v[68:71], v[20:23], v[152:155], v[68:71]
    ds_read_b64_tr_b16 v[18:19], v88 offset:6400
    s_waitcnt lgkmcnt(8)
    v_mfma_f32_16x16x32_bf16 v[32:35], v[24:27], v[156:159], v[32:35]
    ds_read_b64_tr_b16 v[20:21], v88 offset:5160
    v_mfma_f32_16x16x32_bf16 v[36:39], v[24:27], v[160:163], v[36:39]
    ds_read_b64_tr_b16 v[22:23], v88 offset:6440
    v_mfma_f32_16x16x32_bf16 v[40:43], v[28:31], v[156:159], v[40:43]
    ds_read_b64_tr_b16 v[24:25], v88 offset:5200
    v_mfma_f32_16x16x32_bf16 v[44:47], v[28:31], v[160:163], v[44:47]
    ds_read_b64_tr_b16 v[26:27], v88 offset:6480
    s_waitcnt lgkmcnt(8)
    v_mfma_f32_16x16x32_bf16 v[48:51], v[4:7], v[156:159], v[48:51]
    ds_read_b64_tr_b16 v[28:29], v88 offset:5240
    v_mfma_f32_16x16x32_bf16 v[52:55], v[4:7], v[160:163], v[52:55]
    ds_read_b64_tr_b16 v[30:31], v88 offset:6520
    v_mfma_f32_16x16x32_bf16 v[56:59], v[8:11], v[156:159], v[56:59]
    ds_read_b64_tr_b16 v[4:5], v89 offset:5152
    v_mfma_f32_16x16x32_bf16 v[60:63], v[8:11], v[160:163], v[60:63]
    ds_read_b64_tr_b16 v[6:7], v89 offset:6432
    s_waitcnt lgkmcnt(8)
    v_mfma_f32_16x16x32_bf16 v[64:67], v[12:15], v[156:159], v[64:67]
    v_subrev_u32 v88, 51200, v88
    v_subrev_u32 v89, 51200, v89
    ds_read_b64_tr_b16 v[8:9], v88 offset:40960
    v_mfma_f32_16x16x32_bf16 v[68:71], v[12:15], v[160:163], v[68:71]
    ds_read_b64_tr_b16 v[10:11], v88 offset:42240
    v_mfma_f32_16x16x32_bf16 v[32:35], v[16:19], v[164:167], v[32:35]
    ds_read_b64_tr_b16 v[12:13], v88 offset:41000
    v_mfma_f32_16x16x32_bf16 v[36:39], v[16:19], v[168:171], v[36:39]
    ds_read_b64_tr_b16 v[14:15], v88 offset:42280
    s_waitcnt lgkmcnt(8)
    v_mfma_f32_16x16x32_bf16 v[40:43], v[20:23], v[164:167], v[40:43]
    ds_read_b64_tr_b16 v[16:17], v88 offset:41040
    v_mfma_f32_16x16x32_bf16 v[44:47], v[20:23], v[168:171], v[44:47]
    ds_read_b64_tr_b16 v[18:19], v88 offset:42320
    v_mfma_f32_16x16x32_bf16 v[48:51], v[24:27], v[164:167], v[48:51]
    ds_read_b64_tr_b16 v[20:21], v88 offset:41080
    v_mfma_f32_16x16x32_bf16 v[52:55], v[24:27], v[168:171], v[52:55]
    ds_read_b64_tr_b16 v[22:23], v88 offset:42360
    s_waitcnt lgkmcnt(8)
    v_mfma_f32_16x16x32_bf16 v[56:59], v[28:31], v[164:167], v[56:59]
    ds_read_b64_tr_b16 v[24:25], v89 offset:40992
    v_mfma_f32_16x16x32_bf16 v[60:63], v[28:31], v[168:171], v[60:63]
    ds_read_b64_tr_b16 v[26:27], v89 offset:42272
    v_mfma_f32_16x16x32_bf16 v[64:67], v[4:7], v[164:167], v[64:67]
    ds_read_b64_tr_b16 v[28:29], v88 offset:46080
    v_mfma_f32_16x16x32_bf16 v[68:71], v[4:7], v[168:171], v[68:71]
    ds_read_b64_tr_b16 v[30:31], v88 offset:47360
    s_waitcnt lgkmcnt(8)
    v_mfma_f32_16x16x32_bf16 v[32:35], v[8:11], v[172:175], v[32:35]
    ds_read_b64_tr_b16 v[4:5], v88 offset:46120
    v_mov_b32 v86, 163824
    v_mfma_f32_16x16x32_bf16 v[36:39], v[8:11], v[176:179], v[36:39]
    ds_read_b64_tr_b16 v[6:7], v88 offset:47400
    v_mov_b32_e64 v87, 1
    v_mfma_f32_16x16x32_bf16 v[40:43], v[12:15], v[172:175], v[40:43]
    ds_read_b64_tr_b16 v[8:9], v88 offset:46160
    s_mov_b64 exec, 1
    ds_add_u32 v86, v87
    s_mov_b64 exec, -1
    v_mfma_f32_16x16x32_bf16 v[44:47], v[12:15], v[176:179], v[44:47]
    ds_read_b64_tr_b16 v[10:11], v88 offset:47440
    v_mov_b32 v152, 0
    s_waitcnt lgkmcnt(9)
    v_mfma_f32_16x16x32_bf16 v[48:51], v[16:19], v[172:175], v[48:51]
    ds_read_b64_tr_b16 v[12:13], v88 offset:46200
    v_mov_b32_e64 v153, 0
    v_mfma_f32_16x16x32_bf16 v[52:55], v[16:19], v[176:179], v[52:55]
    ds_read_b64_tr_b16 v[14:15], v88 offset:47480
    v_mov_b32_e64 v154, 0
    v_mfma_f32_16x16x32_bf16 v[56:59], v[20:23], v[172:175], v[56:59]
    ds_read_b64_tr_b16 v[16:17], v89 offset:46112
    v_mov_b32_e64 v155, 0
    v_mfma_f32_16x16x32_bf16 v[60:63], v[20:23], v[176:179], v[60:63]
    ds_read_b64_tr_b16 v[18:19], v89 offset:47392
    v_mov_b32 v156, 0
    s_waitcnt lgkmcnt(9)
    v_mfma_f32_16x16x32_bf16 v[64:67], v[24:27], v[172:175], v[64:67]
    ds_read_b64_tr_b16 v[20:21], v88 offset:30720
    v_mov_b32_e64 v157, 0
    v_mfma_f32_16x16x32_bf16 v[68:71], v[24:27], v[176:179], v[68:71]
    ds_read_b64_tr_b16 v[22:23], v88 offset:32000
    v_mov_b32_e64 v158, 0
    v_mfma_f32_16x16x32_bf16 v[32:35], v[28:31], v[180:183], v[32:35]
    ds_read_b64_tr_b16 v[24:25], v88 offset:30760
    v_mov_b32_e64 v159, 0
    v_mfma_f32_16x16x32_bf16 v[36:39], v[28:31], v[184:187], v[36:39]
    ds_read_b64_tr_b16 v[26:27], v88 offset:32040
    v_mov_b32 v160, 0
    s_waitcnt lgkmcnt(8)
    v_mfma_f32_16x16x32_bf16 v[40:43], v[4:7], v[180:183], v[40:43]
    ds_read_b64_tr_b16 v[28:29], v88 offset:30800
    v_mov_b32_e64 v161, 0
    v_mfma_f32_16x16x32_bf16 v[44:47], v[4:7], v[184:187], v[44:47]
    ds_read_b64_tr_b16 v[30:31], v88 offset:32080
    v_mov_b32_e64 v162, 0
    v_mfma_f32_16x16x32_bf16 v[48:51], v[8:11], v[180:183], v[48:51]
    ds_read_b64_tr_b16 v[4:5], v88 offset:30840
    v_mov_b32_e64 v163, 0
    v_mfma_f32_16x16x32_bf16 v[52:55], v[8:11], v[184:187], v[52:55]
    ds_read_b64_tr_b16 v[6:7], v88 offset:32120
    v_mov_b32 v164, 0
    s_waitcnt lgkmcnt(8)
    v_mfma_f32_16x16x32_bf16 v[56:59], v[12:15], v[180:183], v[56:59]
    ds_read_b64_tr_b16 v[8:9], v89 offset:30752
    v_mov_b32_e64 v165, 0
    v_mfma_f32_16x16x32_bf16 v[60:63], v[12:15], v[184:187], v[60:63]
    ds_read_b64_tr_b16 v[10:11], v89 offset:32032
    v_mov_b32_e64 v166, 0
    v_mfma_f32_16x16x32_bf16 v[64:67], v[16:19], v[180:183], v[64:67]
    ds_read_b64_tr_b16 v[12:13], v88 offset:35840
    v_mov_b32_e64 v167, 0
    v_mfma_f32_16x16x32_bf16 v[68:71], v[16:19], v[184:187], v[68:71]
    ds_read_b64_tr_b16 v[14:15], v88 offset:37120
    s_waitcnt lgkmcnt(8)
    v_mfma_f32_16x16x32_bf16 v[32:35], v[20:23], v[188:191], v[32:35]
    ds_read_b64_tr_b16 v[16:17], v88 offset:35880
    v_mfma_f32_16x16x32_bf16 v[36:39], v[20:23], v[192:195], v[36:39]
    ds_read_b64_tr_b16 v[18:19], v88 offset:37160
    v_mfma_f32_16x16x32_bf16 v[40:43], v[24:27], v[188:191], v[40:43]
    ds_read_b64_tr_b16 v[20:21], v88 offset:35920
    v_mfma_f32_16x16x32_bf16 v[44:47], v[24:27], v[192:195], v[44:47]
    ds_read_b64_tr_b16 v[22:23], v88 offset:37200
    s_waitcnt lgkmcnt(8)
    v_mfma_f32_16x16x32_bf16 v[48:51], v[28:31], v[188:191], v[48:51]
    ds_read_b64_tr_b16 v[24:25], v88 offset:35960
    v_mfma_f32_16x16x32_bf16 v[52:55], v[28:31], v[192:195], v[52:55]
    ds_read_b64_tr_b16 v[26:27], v88 offset:37240
    v_mfma_f32_16x16x32_bf16 v[56:59], v[4:7], v[188:191], v[56:59]
    ds_read_b64_tr_b16 v[28:29], v89 offset:35872
    v_mfma_f32_16x16x32_bf16 v[60:63], v[4:7], v[192:195], v[60:63]
    ds_read_b64_tr_b16 v[30:31], v89 offset:37152
    s_waitcnt lgkmcnt(8)
    v_mfma_f32_16x16x32_bf16 v[64:67], v[8:11], v[188:191], v[64:67]
    ds_read_b64_tr_b16 v[4:5], v88 offset:20480
    v_mfma_f32_16x16x32_bf16 v[68:71], v[8:11], v[192:195], v[68:71]
    ds_read_b64_tr_b16 v[6:7], v88 offset:21760
    v_mfma_f32_16x16x32_bf16 v[32:35], v[12:15], v[196:199], v[32:35]
    ds_read_b64_tr_b16 v[8:9], v88 offset:20520
    v_mfma_f32_16x16x32_bf16 v[36:39], v[12:15], v[200:203], v[36:39]
    ds_read_b64_tr_b16 v[10:11], v88 offset:21800
    s_waitcnt lgkmcnt(8)
    v_mfma_f32_16x16x32_bf16 v[40:43], v[16:19], v[196:199], v[40:43]
    ds_read_b64_tr_b16 v[12:13], v88 offset:20560
    v_mfma_f32_16x16x32_bf16 v[44:47], v[16:19], v[200:203], v[44:47]
    ds_read_b64_tr_b16 v[14:15], v88 offset:21840
    v_mfma_f32_16x16x32_bf16 v[48:51], v[20:23], v[196:199], v[48:51]
    ds_read_b64_tr_b16 v[16:17], v88 offset:20600
    v_mfma_f32_16x16x32_bf16 v[52:55], v[20:23], v[200:203], v[52:55]
    ds_read_b64_tr_b16 v[18:19], v88 offset:21880
    s_waitcnt lgkmcnt(8)
    v_mfma_f32_16x16x32_bf16 v[56:59], v[24:27], v[196:199], v[56:59]
    ds_read_b64_tr_b16 v[20:21], v89 offset:20512
    v_mfma_f32_16x16x32_bf16 v[60:63], v[24:27], v[200:203], v[60:63]
    ds_read_b64_tr_b16 v[22:23], v89 offset:21792
    v_mfma_f32_16x16x32_bf16 v[64:67], v[28:31], v[196:199], v[64:67]
    ds_read_b64_tr_b16 v[24:25], v88 offset:25600
    v_mfma_f32_16x16x32_bf16 v[68:71], v[28:31], v[200:203], v[68:71]
    ds_read_b64_tr_b16 v[26:27], v88 offset:26880
    s_waitcnt lgkmcnt(8)
    v_mfma_f32_16x16x32_bf16 v[32:35], v[4:7], v[204:207], v[32:35]
    ds_read_b64_tr_b16 v[28:29], v88 offset:25640
    v_mfma_f32_16x16x32_bf16 v[36:39], v[4:7], v[208:211], v[36:39]
    ds_read_b64_tr_b16 v[30:31], v88 offset:26920
    v_mfma_f32_16x16x32_bf16 v[40:43], v[8:11], v[204:207], v[40:43]
    ds_read_b64_tr_b16 v[4:5], v88 offset:25680
    v_mfma_f32_16x16x32_bf16 v[44:47], v[8:11], v[208:211], v[44:47]
    ds_read_b64_tr_b16 v[6:7], v88 offset:26960
    s_waitcnt lgkmcnt(8)
    v_mfma_f32_16x16x32_bf16 v[48:51], v[12:15], v[204:207], v[48:51]
    ds_read_b64_tr_b16 v[8:9], v88 offset:25720
    v_mfma_f32_16x16x32_bf16 v[52:55], v[12:15], v[208:211], v[52:55]
    ds_read_b64_tr_b16 v[10:11], v88 offset:27000
    v_mfma_f32_16x16x32_bf16 v[56:59], v[16:19], v[204:207], v[56:59]
    ds_read_b64_tr_b16 v[12:13], v89 offset:25632
    v_mfma_f32_16x16x32_bf16 v[60:63], v[16:19], v[208:211], v[60:63]
    ds_read_b64_tr_b16 v[14:15], v89 offset:26912
    s_waitcnt lgkmcnt(8)
    v_mfma_f32_16x16x32_bf16 v[64:67], v[20:23], v[204:207], v[64:67]
    ds_read_b64_tr_b16 v[16:17], v88 offset:10240
    v_mfma_f32_16x16x32_bf16 v[68:71], v[20:23], v[208:211], v[68:71]
    ds_read_b64_tr_b16 v[18:19], v88 offset:11520
    v_mfma_f32_16x16x32_bf16 v[32:35], v[24:27], v[212:215], v[32:35]
    ds_read_b64_tr_b16 v[20:21], v88 offset:10280
    v_mfma_f32_16x16x32_bf16 v[36:39], v[24:27], v[216:219], v[36:39]
    ds_read_b64_tr_b16 v[22:23], v88 offset:11560
    s_waitcnt lgkmcnt(8)
    v_mfma_f32_16x16x32_bf16 v[40:43], v[28:31], v[212:215], v[40:43]
    ds_read_b64_tr_b16 v[24:25], v88 offset:10320
    v_mfma_f32_16x16x32_bf16 v[44:47], v[28:31], v[216:219], v[44:47]
    ds_read_b64_tr_b16 v[26:27], v88 offset:11600
    v_mfma_f32_16x16x32_bf16 v[48:51], v[4:7], v[212:215], v[48:51]
    ds_read_b64_tr_b16 v[28:29], v88 offset:10360
    v_mfma_f32_16x16x32_bf16 v[52:55], v[4:7], v[216:219], v[52:55]
    ds_read_b64_tr_b16 v[30:31], v88 offset:11640
    s_waitcnt lgkmcnt(8)
    v_mfma_f32_16x16x32_bf16 v[56:59], v[8:11], v[212:215], v[56:59]
    ds_read_b64_tr_b16 v[4:5], v89 offset:10272
    v_mfma_f32_16x16x32_bf16 v[60:63], v[8:11], v[216:219], v[60:63]
    ds_read_b64_tr_b16 v[6:7], v89 offset:11552
    v_mfma_f32_16x16x32_bf16 v[64:67], v[12:15], v[212:215], v[64:67]
    ds_read_b64_tr_b16 v[8:9], v88 offset:15360
    v_mfma_f32_16x16x32_bf16 v[68:71], v[12:15], v[216:219], v[68:71]
    ds_read_b64_tr_b16 v[10:11], v88 offset:16640
    s_waitcnt lgkmcnt(8)
    v_mfma_f32_16x16x32_bf16 v[32:35], v[16:19], v[220:223], v[32:35]
    ds_read_b64_tr_b16 v[12:13], v88 offset:15400
    v_mfma_f32_16x16x32_bf16 v[36:39], v[16:19], v[224:227], v[36:39]
    ds_read_b64_tr_b16 v[14:15], v88 offset:16680
    v_mfma_f32_16x16x32_bf16 v[40:43], v[20:23], v[220:223], v[40:43]
    ds_read_b64_tr_b16 v[16:17], v88 offset:15440
    v_mfma_f32_16x16x32_bf16 v[44:47], v[20:23], v[224:227], v[44:47]
    ds_read_b64_tr_b16 v[18:19], v88 offset:16720
    s_waitcnt lgkmcnt(8)
    v_mfma_f32_16x16x32_bf16 v[48:51], v[24:27], v[220:223], v[48:51]
    ds_read_b64_tr_b16 v[20:21], v88 offset:15480
    v_mfma_f32_16x16x32_bf16 v[52:55], v[24:27], v[224:227], v[52:55]
    ds_read_b64_tr_b16 v[22:23], v88 offset:16760
    v_mfma_f32_16x16x32_bf16 v[56:59], v[28:31], v[220:223], v[56:59]
    ds_read_b64_tr_b16 v[24:25], v89 offset:15392
    v_mfma_f32_16x16x32_bf16 v[60:63], v[28:31], v[224:227], v[60:63]
    ds_read_b64_tr_b16 v[26:27], v89 offset:16672
    s_waitcnt lgkmcnt(8)
    v_mfma_f32_16x16x32_bf16 v[64:67], v[4:7], v[220:223], v[64:67]
    ds_read_b64_tr_b16 v[28:29], v88 offset:0
    v_mfma_f32_16x16x32_bf16 v[68:71], v[4:7], v[224:227], v[68:71]
    ds_read_b64_tr_b16 v[30:31], v88 offset:1280
    v_mfma_f32_16x16x32_bf16 v[32:35], v[8:11], v[228:231], v[32:35]
    ds_read_b64_tr_b16 v[4:5], v88 offset:40
    v_mfma_f32_16x16x32_bf16 v[36:39], v[8:11], v[232:235], v[36:39]
    ds_read_b64_tr_b16 v[6:7], v88 offset:1320
    s_waitcnt lgkmcnt(8)
    v_mfma_f32_16x16x32_bf16 v[40:43], v[12:15], v[228:231], v[40:43]
    ds_read_b64_tr_b16 v[8:9], v88 offset:80
    v_mfma_f32_16x16x32_bf16 v[44:47], v[12:15], v[232:235], v[44:47]
    ds_read_b64_tr_b16 v[10:11], v88 offset:1360
    v_mfma_f32_16x16x32_bf16 v[48:51], v[16:19], v[228:231], v[48:51]
    ds_read_b64_tr_b16 v[12:13], v88 offset:120
    v_mfma_f32_16x16x32_bf16 v[52:55], v[16:19], v[232:235], v[52:55]
    ds_read_b64_tr_b16 v[14:15], v88 offset:1400
    s_waitcnt lgkmcnt(8)
    v_mfma_f32_16x16x32_bf16 v[56:59], v[20:23], v[228:231], v[56:59]
    ds_read_b64_tr_b16 v[16:17], v89 offset:32
    v_mfma_f32_16x16x32_bf16 v[60:63], v[20:23], v[232:235], v[60:63]
    ds_read_b64_tr_b16 v[18:19], v89 offset:1312
    v_mfma_f32_16x16x32_bf16 v[64:67], v[24:27], v[228:231], v[64:67]
    ds_read_b64_tr_b16 v[20:21], v88 offset:5120
    v_mfma_f32_16x16x32_bf16 v[68:71], v[24:27], v[232:235], v[68:71]
    ds_read_b64_tr_b16 v[22:23], v88 offset:6400
    s_waitcnt lgkmcnt(8)
    v_mfma_f32_16x16x32_bf16 v[32:35], v[28:31], v[236:239], v[32:35]
    ds_read_b64_tr_b16 v[24:25], v88 offset:5160
    v_mfma_f32_16x16x32_bf16 v[36:39], v[28:31], v[240:243], v[36:39]
    ds_read_b64_tr_b16 v[26:27], v88 offset:6440
    v_mfma_f32_16x16x32_bf16 v[40:43], v[4:7], v[236:239], v[40:43]
    ds_read_b64_tr_b16 v[28:29], v88 offset:5200
    v_mfma_f32_16x16x32_bf16 v[44:47], v[4:7], v[240:243], v[44:47]
    ds_read_b64_tr_b16 v[30:31], v88 offset:6480
    s_waitcnt lgkmcnt(8)
    v_mfma_f32_16x16x32_bf16 v[48:51], v[8:11], v[236:239], v[48:51]
    ds_read_b64_tr_b16 v[4:5], v88 offset:5240
    v_mfma_f32_16x16x32_bf16 v[52:55], v[8:11], v[240:243], v[52:55]
    ds_read_b64_tr_b16 v[6:7], v88 offset:6520
    v_mfma_f32_16x16x32_bf16 v[56:59], v[12:15], v[236:239], v[56:59]
    ds_read_b64_tr_b16 v[8:9], v89 offset:5152
    v_mfma_f32_16x16x32_bf16 v[60:63], v[12:15], v[240:243], v[60:63]
    ds_read_b64_tr_b16 v[10:11], v89 offset:6432
    s_waitcnt lgkmcnt(8)
    v_mfma_f32_16x16x32_bf16 v[64:67], v[16:19], v[236:239], v[64:67]
    v_mfma_f32_16x16x32_bf16 v[68:71], v[16:19], v[240:243], v[68:71]
    v_mfma_f32_16x16x32_bf16 v[32:35], v[20:23], v[244:247], v[32:35]
    v_mfma_f32_16x16x32_bf16 v[36:39], v[20:23], v[248:251], v[36:39]
    s_waitcnt lgkmcnt(4)
    v_mfma_f32_16x16x32_bf16 v[40:43], v[24:27], v[244:247], v[40:43]
    v_mfma_f32_16x16x32_bf16 v[44:47], v[24:27], v[248:251], v[44:47]
    v_mfma_f32_16x16x32_bf16 v[48:51], v[28:31], v[244:247], v[48:51]
    v_mfma_f32_16x16x32_bf16 v[52:55], v[28:31], v[248:251], v[52:55]
    s_waitcnt lgkmcnt(0)
    v_mfma_f32_16x16x32_bf16 v[56:59], v[4:7], v[244:247], v[56:59]
    v_mfma_f32_16x16x32_bf16 v[60:63], v[4:7], v[248:251], v[60:63]
    v_mfma_f32_16x16x32_bf16 v[64:67], v[8:11], v[244:247], v[64:67]
    v_mfma_f32_16x16x32_bf16 v[68:71], v[8:11], v[248:251], v[68:71]
    v_mov_b32 v74, 163824
    v_mov_b32 v75, 0x10000
    s_mov_b64 exec, 1
    ds_add_u32 v74, v75
    s_mov_b64 exec, -1
    v_pk_fma_f32 v[92:93], v[32:33], v[80:81], v[80:81] op_sel_hi:[1,0,0] neg_lo:[0,0,1] neg_hi:[0,0,1]
    v_pk_fma_f32 v[94:95], v[34:35], v[80:81], v[80:81] op_sel_hi:[1,0,0] neg_lo:[0,0,1] neg_hi:[0,0,1]
    v_pk_fma_f32 v[96:97], v[36:37], v[80:81], v[80:81] op_sel_hi:[1,0,0] neg_lo:[0,0,1] neg_hi:[0,0,1]
    v_pk_fma_f32 v[98:99], v[38:39], v[80:81], v[80:81] op_sel_hi:[1,0,0] neg_lo:[0,0,1] neg_hi:[0,0,1]
    v_pk_fma_f32 v[100:101], v[40:41], v[80:81], v[80:81] op_sel_hi:[1,0,0] neg_lo:[0,0,1] neg_hi:[0,0,1]
    v_pk_fma_f32 v[102:103], v[42:43], v[80:81], v[80:81] op_sel_hi:[1,0,0] neg_lo:[0,0,1] neg_hi:[0,0,1]
    v_pk_fma_f32 v[104:105], v[44:45], v[80:81], v[80:81] op_sel_hi:[1,0,0] neg_lo:[0,0,1] neg_hi:[0,0,1]
    v_pk_fma_f32 v[106:107], v[46:47], v[80:81], v[80:81] op_sel_hi:[1,0,0] neg_lo:[0,0,1] neg_hi:[0,0,1]
    v_pk_fma_f32 v[108:109], v[48:49], v[80:81], v[80:81] op_sel_hi:[1,0,0] neg_lo:[0,0,1] neg_hi:[0,0,1]
    v_pk_fma_f32 v[110:111], v[50:51], v[80:81], v[80:81] op_sel_hi:[1,0,0] neg_lo:[0,0,1] neg_hi:[0,0,1]
    v_pk_fma_f32 v[112:113], v[52:53], v[80:81], v[80:81] op_sel_hi:[1,0,0] neg_lo:[0,0,1] neg_hi:[0,0,1]
    v_pk_fma_f32 v[114:115], v[54:55], v[80:81], v[80:81] op_sel_hi:[1,0,0] neg_lo:[0,0,1] neg_hi:[0,0,1]
    v_pk_fma_f32 v[116:117], v[56:57], v[80:81], v[80:81] op_sel_hi:[1,0,0] neg_lo:[0,0,1] neg_hi:[0,0,1]
    v_pk_fma_f32 v[118:119], v[58:59], v[80:81], v[80:81] op_sel_hi:[1,0,0] neg_lo:[0,0,1] neg_hi:[0,0,1]
    v_pk_fma_f32 v[120:121], v[60:61], v[80:81], v[80:81] op_sel_hi:[1,0,0] neg_lo:[0,0,1] neg_hi:[0,0,1]
    v_pk_fma_f32 v[122:123], v[62:63], v[80:81], v[80:81] op_sel_hi:[1,0,0] neg_lo:[0,0,1] neg_hi:[0,0,1]
    v_pk_fma_f32 v[124:125], v[64:65], v[80:81], v[80:81] op_sel_hi:[1,0,0] neg_lo:[0,0,1] neg_hi:[0,0,1]
    v_pk_fma_f32 v[126:127], v[66:67], v[80:81], v[80:81] op_sel_hi:[1,0,0] neg_lo:[0,0,1] neg_hi:[0,0,1]
    v_pk_fma_f32 v[128:129], v[68:69], v[80:81], v[80:81] op_sel_hi:[1,0,0] neg_lo:[0,0,1] neg_hi:[0,0,1]
    v_pk_fma_f32 v[130:131], v[70:71], v[80:81], v[80:81] op_sel_hi:[1,0,0] neg_lo:[0,0,1] neg_hi:[0,0,1]
    v_exp_f32_e64 v92, v92 clamp
    v_exp_f32_e64 v93, v93 clamp
    v_exp_f32_e64 v94, v94 clamp
    v_exp_f32_e64 v95, v95 clamp
    v_exp_f32_e64 v96, v96 clamp
    v_exp_f32_e64 v97, v97 clamp
    v_exp_f32_e64 v98, v98 clamp
    v_exp_f32_e64 v99, v99 clamp
    v_exp_f32_e64 v100, v100 clamp
    v_exp_f32_e64 v101, v101 clamp
    v_exp_f32_e64 v102, v102 clamp
    v_exp_f32_e64 v103, v103 clamp
    v_exp_f32_e64 v104, v104 clamp
    v_exp_f32_e64 v105, v105 clamp
    v_exp_f32_e64 v106, v106 clamp
    v_exp_f32_e64 v107, v107 clamp
    v_exp_f32_e64 v108, v108 clamp
    v_exp_f32_e64 v109, v109 clamp
    v_exp_f32_e64 v110, v110 clamp
    v_exp_f32_e64 v111, v111 clamp
    v_exp_f32_e64 v112, v112 clamp
    v_exp_f32_e64 v113, v113 clamp
    v_exp_f32_e64 v114, v114 clamp
    v_exp_f32_e64 v115, v115 clamp
    v_exp_f32_e64 v116, v116 clamp
    v_exp_f32_e64 v117, v117 clamp
    v_exp_f32_e64 v118, v118 clamp
    v_exp_f32_e64 v119, v119 clamp
    v_exp_f32_e64 v120, v120 clamp
    v_exp_f32_e64 v121, v121 clamp
    v_exp_f32_e64 v122, v122 clamp
    v_exp_f32_e64 v123, v123 clamp
    v_exp_f32_e64 v124, v124 clamp
    v_exp_f32_e64 v125, v125 clamp
    v_exp_f32_e64 v126, v126 clamp
    v_exp_f32_e64 v127, v127 clamp
    v_exp_f32_e64 v128, v128 clamp
    v_exp_f32_e64 v129, v129 clamp
    v_exp_f32_e64 v130, v130 clamp
    v_exp_f32_e64 v131, v131 clamp
    v_max_f32 v92, v92, v32
    v_max_f32 v93, v93, v33
    v_max_f32 v94, v94, v34
    v_max_f32 v95, v95, v35
    v_max_f32 v96, v96, v36
    v_max_f32 v97, v97, v37
    v_max_f32 v98, v98, v38
    v_max_f32 v99, v99, v39
    v_max_f32 v100, v100, v40
    v_max_f32 v101, v101, v41
    v_max_f32 v102, v102, v42
    v_max_f32 v103, v103, v43
    v_max_f32 v104, v104, v44
    v_max_f32 v105, v105, v45
    v_max_f32 v106, v106, v46
    v_max_f32 v107, v107, v47
    v_max_f32 v108, v108, v48
    v_max_f32 v109, v109, v49
    v_max_f32 v110, v110, v50
    v_max_f32 v111, v111, v51
    v_max_f32 v112, v112, v52
    v_max_f32 v113, v113, v53
    v_max_f32 v114, v114, v54
    v_max_f32 v115, v115, v55
    v_max_f32 v116, v116, v56
    v_max_f32 v117, v117, v57
    v_max_f32 v118, v118, v58
    v_max_f32 v119, v119, v59
    v_max_f32 v120, v120, v60
    v_max_f32 v121, v121, v61
    v_max_f32 v122, v122, v62
    v_max_f32 v123, v123, v63
    v_max_f32 v124, v124, v64
    v_max_f32 v125, v125, v65
    v_max_f32 v126, v126, v66
    v_max_f32 v127, v127, v67
    v_max_f32 v128, v128, v68
    v_max_f32 v129, v129, v69
    v_max_f32 v130, v130, v70
    v_max_f32 v131, v131, v71
    v_pk_add_f32 v[92:93], v[92:93], v[80:81] op_sel:[0,1] op_sel_hi:[1,1]
    v_pk_add_f32 v[94:95], v[94:95], v[80:81] op_sel:[0,1] op_sel_hi:[1,1]
    v_pk_add_f32 v[96:97], v[96:97], v[80:81] op_sel:[0,1] op_sel_hi:[1,1]
    v_pk_add_f32 v[98:99], v[98:99], v[80:81] op_sel:[0,1] op_sel_hi:[1,1]
    v_pk_add_f32 v[100:101], v[100:101], v[80:81] op_sel:[0,1] op_sel_hi:[1,1]
    v_pk_add_f32 v[102:103], v[102:103], v[80:81] op_sel:[0,1] op_sel_hi:[1,1]
    v_pk_add_f32 v[104:105], v[104:105], v[80:81] op_sel:[0,1] op_sel_hi:[1,1]
    v_pk_add_f32 v[106:107], v[106:107], v[80:81] op_sel:[0,1] op_sel_hi:[1,1]
    v_pk_add_f32 v[108:109], v[108:109], v[80:81] op_sel:[0,1] op_sel_hi:[1,1]
    v_pk_add_f32 v[110:111], v[110:111], v[80:81] op_sel:[0,1] op_sel_hi:[1,1]
    v_pk_add_f32 v[112:113], v[112:113], v[80:81] op_sel:[0,1] op_sel_hi:[1,1]
    v_pk_add_f32 v[114:115], v[114:115], v[80:81] op_sel:[0,1] op_sel_hi:[1,1]
    v_pk_add_f32 v[116:117], v[116:117], v[80:81] op_sel:[0,1] op_sel_hi:[1,1]
    v_pk_add_f32 v[118:119], v[118:119], v[80:81] op_sel:[0,1] op_sel_hi:[1,1]
    v_pk_add_f32 v[120:121], v[120:121], v[80:81] op_sel:[0,1] op_sel_hi:[1,1]
    v_pk_add_f32 v[122:123], v[122:123], v[80:81] op_sel:[0,1] op_sel_hi:[1,1]
    v_pk_add_f32 v[124:125], v[124:125], v[80:81] op_sel:[0,1] op_sel_hi:[1,1]
    v_pk_add_f32 v[126:127], v[126:127], v[80:81] op_sel:[0,1] op_sel_hi:[1,1]
    v_pk_add_f32 v[128:129], v[128:129], v[80:81] op_sel:[0,1] op_sel_hi:[1,1]
    v_pk_add_f32 v[130:131], v[130:131], v[80:81] op_sel:[0,1] op_sel_hi:[1,1]
    v_cvt_pk_bf16_f32 v132, v92, v93
    v_cvt_pk_bf16_f32 v133, v94, v95
    v_cvt_pk_bf16_f32 v134, v96, v97
    v_cvt_pk_bf16_f32 v135, v98, v99
    v_cvt_pk_bf16_f32 v136, v100, v101
    v_cvt_pk_bf16_f32 v137, v102, v103
    v_cvt_pk_bf16_f32 v138, v104, v105
    v_cvt_pk_bf16_f32 v139, v106, v107
    v_cvt_pk_bf16_f32 v140, v108, v109
    v_cvt_pk_bf16_f32 v141, v110, v111
    v_cvt_pk_bf16_f32 v142, v112, v113
    v_cvt_pk_bf16_f32 v143, v114, v115
    v_cvt_pk_bf16_f32 v144, v116, v117
    v_cvt_pk_bf16_f32 v145, v118, v119
    v_cvt_pk_bf16_f32 v146, v120, v121
    v_cvt_pk_bf16_f32 v147, v122, v123
    v_cvt_pk_bf16_f32 v148, v124, v125
    v_cvt_pk_bf16_f32 v149, v126, v127
    v_cvt_pk_bf16_f32 v150, v128, v129
    v_cvt_pk_bf16_f32 v151, v130, v131
    v_permlane16_swap_b32 v132, v134
    v_permlane16_swap_b32 v133, v135
    v_permlane16_swap_b32 v136, v138
    v_permlane16_swap_b32 v137, v139
    v_permlane16_swap_b32 v140, v142
    v_permlane16_swap_b32 v141, v143
    v_permlane16_swap_b32 v144, v146
    v_permlane16_swap_b32 v145, v147
    s_add_u32 s48, s46, 1048576
    s_addc_u32 s49, s47, 0
    s_mov_b32 s50, 2621440
    s_mov_b32 s51, 0x20000
    v_lshlrev_b32_e64 v86, 4, v1
    s_lshl_b32 s6, s61, 2
    s_add_u32 s6, s6, s5
    s_lshl_b32 s8, s6, 7
    s_add_u32 s8, s8, 65536
    v_lshl_add_u32 v87, v1, 2, s8
    s_mul_i32 s6, s6, 40960
    s_mul_i32 s7, s62, 5120
    s_add_u32 s6, s6, s7
    s_add_u32 s7, s6, 4096
    s_add_u32 s55, s6, 1048576
    v_permlane16_swap_b32 v148, v150
    v_permlane16_swap_b32 v149, v151
    v_mov_b32 v72, 163824
Lg_kw_19:
    ds_read_b32 v73, v72
    s_waitcnt lgkmcnt(0)
    v_cmp_gt_u32 vcc, 0x1000000, v73
    s_cbranch_vccnz Lg_kw_19
    ds_read_b32 v83, v91
    s_mov_b32 exec_hi, 0
    ds_read_b64 v[152:153], v84 offset:40992
    ds_read_b64 v[158:159], v84 offset:41832
    s_not_b64 exec, exec
    ds_read_b64 v[160:161], v84 offset:42672
    ds_read_b64 v[166:167], v84 offset:43512
    s_mov_b64 exec, -1
    ds_read_b64 v[168:169], v85 offset:40960
    ds_read_b64 v[170:171], v85 offset:40968
    ds_read_b64 v[172:173], v85 offset:41800
    ds_read_b64 v[174:175], v85 offset:41808
    ds_read_b64 v[176:177], v85 offset:42640
    ds_read_b64 v[178:179], v85 offset:42648
    ds_read_b64 v[180:181], v85 offset:43480
    ds_read_b64 v[182:183], v85 offset:43488
    s_waitcnt lgkmcnt(11)
    v_mfma_f32_32x32x16_bf16 v[184:199], v[152:155], v[148:151], 0
    v_cvt_pk_bf16_f32 v83, v83, v83
    v_and_b32 v83, 0xffff0000, v83
    v_mul_f32 v83, 0xbfb8aa3b, v83
    v_exp_f32 v83, v83
    s_waitcnt lgkmcnt(6)
    v_mfma_f32_32x32x16_bf16 v[184:199], v[168:171], v[132:135], v[184:199]
    v_add_f32 v83, 1.0, v83
    v_rcp_f32 v83, v83
    s_nop 0
    v_cvt_pk_bf16_f32 v83, v83, v83
    v_and_b32 v83, 0xffff0000, v83
    v_mfma_f32_32x32x16_bf16 v[200:215], v[156:159], v[148:151], 0
    v_sub_f32_e64 v82, 1.0, v83
    v_cvt_pk_bf16_f32 v82, v82, v82
    v_and_b32 v82, 0xffff0000, v82
    s_waitcnt lgkmcnt(4)
    v_mfma_f32_32x32x16_bf16 v[200:215], v[172:175], v[136:139], v[200:215]
    v_mfma_f32_32x32x16_bf16 v[216:231], v[160:163], v[148:151], 0
    v_add_f32 v194, 0x358637bd, v194
    v_rcp_f32 v194, v194
    s_nop 0
    v_mul_f32 v194, v194, v82
    v_mul_f32 v184, v184, v194
    v_mul_f32 v185, v185, v194
    s_waitcnt lgkmcnt(2)
    v_mfma_f32_32x32x16_bf16 v[216:231], v[176:179], v[140:143], v[216:231]
    v_mul_f32 v186, v186, v194
    v_mul_f32 v187, v187, v194
    v_mul_f32 v188, v188, v194
    v_mul_f32 v189, v189, v194
    v_mul_f32 v190, v190, v194
    v_mfma_f32_32x32x16_bf16 v[232:247], v[164:167], v[148:151], 0
    v_mul_f32 v191, v191, v194
    v_mul_f32 v192, v192, v194
    v_mul_f32_e64 v193, v193, v194
    v_cvt_pk_bf16_f32 v4, v184, v185
    v_cvt_pk_bf16_f32 v5, v186, v187
    s_waitcnt lgkmcnt(0)
    s_nop 0
    v_mfma_f32_32x32x16_bf16 v[232:247], v[180:183], v[144:147], v[232:247]
    v_cvt_pk_bf16_f32 v6, v188, v189
    v_cvt_pk_bf16_f32 v7, v190, v191
    v_cvt_pk_bf16_f32 v8, v192, v193
    v_add_f32 v210, 0x358637bd, v210
    v_add_f32 v226, 0x358637bd, v226
    s_nop 6
    v_add_f32 v242, 0x358637bd, v242
    v_rcp_f32 v210, v210
    v_rcp_f32 v226, v226
    v_rcp_f32 v242, v242
    v_mul_f32 v210, v210, v82
    v_mul_f32 v226, v226, v82
    v_mul_f32_e64 v242, v242, v82
    v_pk_mul_f32 v[200:201], v[200:201], v[210:211] op_sel_hi:[1,0]
    v_pk_mul_f32 v[202:203], v[202:203], v[210:211] op_sel_hi:[1,0]
    v_pk_mul_f32 v[204:205], v[204:205], v[210:211] op_sel_hi:[1,0]
    v_pk_mul_f32 v[206:207], v[206:207], v[210:211] op_sel_hi:[1,0]
    v_pk_mul_f32 v[208:209], v[208:209], v[210:211] op_sel_hi:[1,0]
    v_cvt_pk_bf16_f32 v9, v200, v201
    v_cvt_pk_bf16_f32 v10, v202, v203
    v_cvt_pk_bf16_f32 v11, v204, v205
    v_cvt_pk_bf16_f32 v12, v206, v207
    v_cvt_pk_bf16_f32 v13, v208, v209
    v_pk_mul_f32 v[216:217], v[216:217], v[226:227] op_sel_hi:[1,0]
    v_pk_mul_f32 v[218:219], v[218:219], v[226:227] op_sel_hi:[1,0]
    v_pk_mul_f32 v[220:221], v[220:221], v[226:227] op_sel_hi:[1,0]
    v_pk_mul_f32 v[222:223], v[222:223], v[226:227] op_sel_hi:[1,0]
    v_pk_mul_f32 v[224:225], v[224:225], v[226:227] op_sel_hi:[1,0]
    v_cvt_pk_bf16_f32 v14, v216, v217
    v_cvt_pk_bf16_f32 v15, v218, v219
    v_cvt_pk_bf16_f32 v16, v220, v221
    v_cvt_pk_bf16_f32 v17, v222, v223
    v_cvt_pk_bf16_f32 v18, v224, v225
    v_pk_mul_f32 v[232:233], v[232:233], v[242:243] op_sel_hi:[1,0]
    v_pk_mul_f32 v[234:235], v[234:235], v[242:243] op_sel_hi:[1,0]
    v_pk_mul_f32 v[236:237], v[236:237], v[242:243] op_sel_hi:[1,0]
    v_pk_mul_f32 v[238:239], v[238:239], v[242:243] op_sel_hi:[1,0]
    v_pk_mul_f32 v[240:241], v[240:241], v[242:243] op_sel_hi:[1,0]
    v_cvt_pk_bf16_f32 v19, v232, v233
    v_cvt_pk_bf16_f32 v20, v234, v235
    v_cvt_pk_bf16_f32 v21, v236, v237
    v_cvt_pk_bf16_f32 v22, v238, v239
    v_cvt_pk_bf16_f32 v23, v240, v241
    buffer_store_dwordx4 v[4:7], v86, s[48:51], s6 offen offset:0 sc1
    buffer_store_dwordx4 v[8:11], v86, s[48:51], s6 offen offset:1024 sc1
    buffer_store_dwordx4 v[12:15], v86, s[48:51], s6 offen offset:2048 sc1
    buffer_store_dwordx4 v[16:19], v86, s[48:51], s6 offen offset:3072 sc1
    buffer_store_dwordx4 v[20:23], v86, s[48:51], s7 offen offset:0 sc1
    s_cmp_lg_u32 s62, 0
    s_cbranch_scc1 Lg_ng_20
    s_mov_b32 exec_hi, 0
    global_store_dword v87, v83, s[46:47] sc1
    s_mov_b32 exec_hi, -1
Lg_ng_20:
    s_setprio 0
    s_mov_b32 s56, 3
    s_branch Lg_end_6
Lg_c_5:
    s_and_b32 s5, s60, 1
    s_lshr_b32 s6, s60, 1
    s_getpc_b64 s[14:15]
Lg_pc_21:
    s_mul_i32 s8, s61, 7
    s_lshr_b32 s8, s8, 2
    s_add_u32 s8, s8, s60
    v_lshlrev_b32 v28, 2, v1
    s_cmp_ge_u32 s8, 28
    s_cselect_b32 s7, 28, 0
    s_sub_u32 s8, s8, s7
    v_lshl_add_u32 v192, s8, 8, v28
    v_lshrrev_b32 v200, 1, v192
    v_add_u32 v200, L_tab_kv-Lg_pc_21, v200
    s_add_u32 s8, s8, 4
    s_cmp_ge_u32 s8, 28
    s_cselect_b32 s7, 28, 0
    s_sub_u32 s8, s8, s7
    v_lshl_add_u32 v193, s8, 8, v28
    v_lshrrev_b32 v201, 1, v193
    v_add_u32 v201, L_tab_kv-Lg_pc_21, v201
    s_add_u32 s8, s8, 4
    s_cmp_ge_u32 s8, 28
    s_cselect_b32 s7, 28, 0
    s_sub_u32 s8, s8, s7
    v_lshl_add_u32 v194, s8, 8, v28
    v_lshrrev_b32 v202, 1, v194
    v_add_u32 v202, L_tab_kv-Lg_pc_21, v202
    s_add_u32 s8, s8, 4
    s_cmp_ge_u32 s8, 28
    s_cselect_b32 s7, 28, 0
    s_sub_u32 s8, s8, s7
    v_lshl_add_u32 v195, s8, 8, v28
    v_lshrrev_b32 v203, 1, v195
    v_add_u32 v203, L_tab_kv-Lg_pc_21, v203
    s_add_u32 s8, s8, 4
    s_cmp_ge_u32 s8, 28
    s_cselect_b32 s7, 28, 0
    s_sub_u32 s8, s8, s7
    v_lshl_add_u32 v196, s8, 8, v28
    v_lshrrev_b32 v204, 1, v196
    v_add_u32 v204, L_tab_kv-Lg_pc_21, v204
    s_add_u32 s8, s8, 4
    s_cmp_ge_u32 s8, 28
    s_cselect_b32 s7, 28, 0
    s_sub_u32 s8, s8, s7
    v_lshl_add_u32 v197, s8, 8, v28
    v_lshrrev_b32 v205, 1, v197
    v_add_u32 v205, L_tab_kv-Lg_pc_21, v205
    s_add_u32 s8, s8, 4
    s_cmp_ge_u32 s8, 28
    s_cselect_b32 s7, 28, 0
    s_sub_u32 s8, s8, s7
    v_lshl_add_u32 v198, s8, 8, v28
    v_lshrrev_b32 v206, 1, v198
    v_add_u32 v206, L_tab_kv-Lg_pc_21, v206
    s_add_u32 s8, s8, 4
    s_waitcnt lgkmcnt(0)
    v_lshrrev_b32 v2, 1, v4
    v_xor_b32 v2, v2, v5
    v_lshlrev_b32 v2, 4, v2
    v_lshl_add_u32 v2, v4, 7, v2
    s_lshl_b32 s8, s6, 13
    s_add_u32 s8, s8, 1280
    v_add_u32 v2, s8, v2
    v_xor_b32 v3, 64, v2
    v_lshrrev_b32 v10, 1, v5
    v_lshlrev_b32 v10, 4, v10
    v_and_b32 v26, 1, v5
    v_lshl_add_u32 v10, v26, 2, v10
    v_lshrrev_b32 v26, 2, v4
    v_add_u32 v10, v10, v26
    v_mul_u32_u24 v10, 160, v10
    v_and_b32 v26, 3, v4
    v_lshl_add_u32 v10, v26, 3, v10
    s_mul_i32 s8, s5, 80
    s_add_u32 s8, s8, 17664
    v_add_u32 v10, s8, v10
    v_cmp_lt_u32 vcc, 1, v26
    v_mov_b32 v30, 64
    v_mov_b32 v31, 10240
    v_cndmask_b32 v30, v30, v31, vcc
    v_add_u32_e64 v11, v10, v30
    v_mov_b32 v8, 0x3fb8aa3b
    v_mov_b32 v9, 0x358637bd
    v_mov_b32_e64 v31, 0
    v_mov_b32 v30, 163820
    ds_write2_b32 v30, v31, v31 offset0:0 offset1:1
    ds_write2_b32 v30, v31, v31 offset0:2 offset1:4
    v_cmp_gt_u32 s[10:11], 8, v4
    s_nop 1
    v_cndmask_b32 v30, 0, 1.0, s[10:11]
    v_mov_b32 v36, 1.0
    v_mov_b32 v37, 1.0
    v_mov_b32 v38, 1.0
    v_mov_b32 v39, 1.0
    v_mov_b32 v40, 1.0
    v_mov_b32 v41, 1.0
    v_mov_b32 v42, 1.0
    v_mov_b32 v43, 1.0
    v_mov_b32 v44, v30
    v_mov_b32 v45, v30
    v_mov_b32 v46, v30
    v_mov_b32 v47, v30
    v_mov_b32 v48, 0
    v_mov_b32 v49, 0
    v_mov_b32 v50, 0
    v_mov_b32 v51, 0
    v_mov_b32 v52, 0
    v_mov_b32 v53, 0
    v_mov_b32 v54, 0
    v_mov_b32 v55, 0
    v_mov_b32 v56, 1.0
    v_mov_b32 v57, 1.0
    v_mov_b32 v58, 1.0
    v_mov_b32 v59, 1.0
    v_mov_b32 v60, 1.0
    v_mov_b32 v61, 1.0
    v_mov_b32 v62, 1.0
    v_mov_b32 v63, 1.0
    v_mov_b32 v64, v30
    v_mov_b32 v65, v30
    v_mov_b32 v66, v30
    v_mov_b32 v67, v30
    v_mov_b32 v68, 0
    v_mov_b32 v69, 0
    v_mov_b32 v70, 0
    v_mov_b32 v71, 0
    v_mov_b32 v72, 0
    v_mov_b32 v73, 0
    v_mov_b32 v74, 0
    v_mov_b32 v75, 0
    v_mov_b32 v76, 1.0
    v_mov_b32 v77, 1.0
    v_mov_b32 v78, 1.0
    v_mov_b32 v79, 1.0
    v_mov_b32 v80, 1.0
    v_mov_b32 v81, 1.0
    v_mov_b32 v82, 1.0
    v_mov_b32 v83, 1.0
    v_mov_b32 v84, v30
    v_mov_b32 v85, v30
    v_mov_b32 v86, v30
    v_mov_b32 v87, v30
    v_mov_b32 v88, 0
    v_mov_b32 v89, 0
    v_mov_b32 v90, 0
    v_mov_b32 v91, 0
    v_mov_b32 v92, 0
    v_mov_b32 v93, 0
    v_mov_b32 v94, 0
    v_mov_b32 v95, 0
    v_mov_b32 v96, 1.0
    v_mov_b32 v97, 1.0
    v_mov_b32 v98, 1.0
    v_mov_b32 v99, 1.0
    v_mov_b32 v100, 1.0
    v_mov_b32 v101, 1.0
    v_mov_b32 v102, 1.0
    v_mov_b32 v103, 1.0
    v_mov_b32 v104, v30
    v_mov_b32 v105, v30
    v_mov_b32 v106, v30
    v_mov_b32 v107, v30
    v_mov_b32 v108, 0
    v_mov_b32 v109, 0
    v_mov_b32 v110, 0
    v_mov_b32 v111, 0
    v_mov_b32 v112, 0
    v_mov_b32 v113, 0
    v_mov_b32 v114, 0
    v_mov_b32 v115, 0
    v_and_b32 v20, 7, v1
    v_lshlrev_b32_e64 v20, 2, v20
    v_mov_b32 v4, 0x3f803f80
    v_mov_b32 v5, 0x3f803f80
    v_mov_b32 v6, 0x3f803f80
    v_mov_b32 v7, 0x3f803f80
    s_mov_b32 s12, 0
    s_mov_b32 s13, 9
    s_mov_b32 s9, 36896
    s_setprio 0
    s_waitcnt vmcnt(0) lgkmcnt(0)
    global_load_ushort v12, v200, s[14:15]
    global_load_ushort v13, v201, s[14:15]
    global_load_ushort v14, v202, s[14:15]
    global_load_ushort v15, v203, s[14:15]
    global_load_ushort v16, v204, s[14:15]
    global_load_ushort v17, v205, s[14:15]
    global_load_ushort v18, v206, s[14:15]
    s_barrier
    ds_read_b128 v[116:119], v2 offset:0
    ds_read_b64_tr_b16 v[132:133], v10 offset:0
    ds_read_b64_tr_b16 v[134:135], v10 offset:1280
    ds_read_b64_tr_b16 v[136:137], v10 offset:32
    ds_read_b64_tr_b16 v[138:139], v10 offset:1312
    ds_read_b64_tr_b16 v[140:141], v11 offset:0
    ds_read_b64_tr_b16 v[142:143], v11 offset:1280
    ds_read_b64_tr_b16 v[144:145], v10 offset:10272
    ds_read_b64_tr_b16 v[146:147], v10 offset:11552
    ds_read_b64_tr_b16 v[148:149], v10 offset:10304
    ds_read_b64_tr_b16 v[150:151], v10 offset:11584
    ds_read_b128 v[120:123], v2 offset:2048
    ds_read_b128 v[124:127], v2 offset:4096
    ds_read_b128 v[128:131], v2 offset:6144
Lg_cl_22:
    s_waitcnt lgkmcnt(0)
    v_mfma_f32_16x16x32_bf16 v[36:39], v[116:119], v[132:135], v[36:39]
    ds_read_b128 v[152:155], v3 offset:0
    v_mfma_f32_16x16x32_bf16 v[40:43], v[116:119], v[136:139], v[40:43]
    ds_read_b64_tr_b16 v[168:169], v10 offset:5120
    v_mfma_f32_16x16x32_bf16 v[44:47], v[116:119], v[140:143], v[44:47]
    ds_read_b64_tr_b16 v[170:171], v10 offset:6400
    v_mfma_f32_16x16x32_bf16 v[48:51], v[116:119], v[144:147], v[48:51]
    ds_read_b64_tr_b16 v[172:173], v10 offset:5152
    v_mfma_f32_16x16x32_bf16 v[52:55], v[116:119], v[148:151], v[52:55]
    ds_read_b64_tr_b16 v[174:175], v10 offset:6432
    v_mfma_f32_16x16x32_bf16 v[56:59], v[120:123], v[132:135], v[56:59]
    ds_read_b64_tr_b16 v[176:177], v11 offset:5120
    v_mfma_f32_16x16x32_bf16 v[60:63], v[120:123], v[136:139], v[60:63]
    ds_read_b64_tr_b16 v[178:179], v11 offset:6400
    v_mfma_f32_16x16x32_bf16 v[64:67], v[120:123], v[140:143], v[64:67]
    ds_read_b64_tr_b16 v[180:181], v10 offset:15392
    v_mfma_f32_16x16x32_bf16 v[68:71], v[120:123], v[144:147], v[68:71]
    ds_read_b64_tr_b16 v[182:183], v10 offset:16672
    v_mfma_f32_16x16x32_bf16 v[72:75], v[120:123], v[148:151], v[72:75]
    ds_read_b64_tr_b16 v[184:185], v10 offset:15424
    v_mfma_f32_16x16x32_bf16 v[76:79], v[124:127], v[132:135], v[76:79]
    ds_read_b64_tr_b16 v[186:187], v10 offset:16704
    v_mfma_f32_16x16x32_bf16 v[80:83], v[124:127], v[136:139], v[80:83]
    ds_read_b128 v[156:159], v3 offset:2048
    v_mfma_f32_16x16x32_bf16 v[84:87], v[124:127], v[140:143], v[84:87]
    ds_read_b128 v[160:163], v3 offset:4096
    v_mfma_f32_16x16x32_bf16 v[88:91], v[124:127], v[144:147], v[88:91]
    ds_read_b128 v[164:167], v3 offset:6144
    v_mfma_f32_16x16x32_bf16 v[92:95], v[124:127], v[148:151], v[92:95]
    s_add_u32 s12, s12, 1
    s_cmp_eq_u32 s12, 3
    s_cselect_b32 s12, 0, s12
    s_cselect_b32 s8, -73792, s9
    v_mfma_f32_16x16x32_bf16 v[96:99], v[128:131], v[132:135], v[96:99]
    v_add_u32 v2, s8, v2
    v_mfma_f32_16x16x32_bf16 v[100:103], v[128:131], v[136:139], v[100:103]
    v_add_u32 v3, s8, v3
    v_mfma_f32_16x16x32_bf16 v[104:107], v[128:131], v[140:143], v[104:107]
    v_add_u32 v10, s8, v10
    v_mfma_f32_16x16x32_bf16 v[108:111], v[128:131], v[144:147], v[108:111]
    v_add_u32 v11, s8, v11
    v_mfma_f32_16x16x32_bf16 v[112:115], v[128:131], v[148:151], v[112:115]
    s_waitcnt lgkmcnt(0)
    s_barrier
    v_mfma_f32_16x16x32_bf16 v[36:39], v[152:155], v[168:171], v[36:39]
    ds_read_b128 v[116:119], v2 offset:0
    v_mfma_f32_16x16x32_bf16 v[40:43], v[152:155], v[172:175], v[40:43]
    ds_read_b64_tr_b16 v[132:133], v10 offset:0
    v_mfma_f32_16x16x32_bf16 v[44:47], v[152:155], v[176:179], v[44:47]
    ds_read_b64_tr_b16 v[134:135], v10 offset:1280
    v_mfma_f32_16x16x32_bf16 v[48:51], v[152:155], v[180:183], v[48:51]
    ds_read_b64_tr_b16 v[136:137], v10 offset:32
    v_mfma_f32_16x16x32_bf16 v[52:55], v[152:155], v[184:187], v[52:55]
    ds_read_b64_tr_b16 v[138:139], v10 offset:1312
    v_mfma_f32_16x16x32_bf16 v[56:59], v[156:159], v[168:171], v[56:59]
    ds_read_b64_tr_b16 v[140:141], v11 offset:0
    v_mfma_f32_16x16x32_bf16 v[60:63], v[156:159], v[172:175], v[60:63]
    ds_read_b64_tr_b16 v[142:143], v11 offset:1280
    v_mfma_f32_16x16x32_bf16 v[64:67], v[156:159], v[176:179], v[64:67]
    ds_read_b64_tr_b16 v[144:145], v10 offset:10272
    v_mfma_f32_16x16x32_bf16 v[68:71], v[156:159], v[180:183], v[68:71]
    ds_read_b64_tr_b16 v[146:147], v10 offset:11552
    v_mfma_f32_16x16x32_bf16 v[72:75], v[156:159], v[184:187], v[72:75]
    ds_read_b64_tr_b16 v[148:149], v10 offset:10304
    v_mfma_f32_16x16x32_bf16 v[76:79], v[160:163], v[168:171], v[76:79]
    ds_read_b64_tr_b16 v[150:151], v10 offset:11584
    v_mfma_f32_16x16x32_bf16 v[80:83], v[160:163], v[172:175], v[80:83]
    ds_read_b128 v[120:123], v2 offset:2048
    v_mfma_f32_16x16x32_bf16 v[84:87], v[160:163], v[176:179], v[84:87]
    ds_read_b128 v[124:127], v2 offset:4096
    v_mfma_f32_16x16x32_bf16 v[88:91], v[160:163], v[180:183], v[88:91]
    ds_read_b128 v[128:131], v2 offset:6144
    v_mfma_f32_16x16x32_bf16 v[92:95], v[160:163], v[184:187], v[92:95]
    s_sub_u32 s13, s13, 1
    s_cmp_lg_u32 s13, 0
    v_mfma_f32_16x16x32_bf16 v[96:99], v[164:167], v[168:171], v[96:99]
    v_mfma_f32_16x16x32_bf16 v[100:103], v[164:167], v[172:175], v[100:103]
    v_mfma_f32_16x16x32_bf16 v[104:107], v[164:167], v[176:179], v[104:107]
    v_mfma_f32_16x16x32_bf16 v[108:111], v[164:167], v[180:183], v[108:111]
    v_mfma_f32_16x16x32_bf16 v[112:115], v[164:167], v[184:187], v[112:115]
    s_cbranch_scc1 Lg_cl_22
    s_waitcnt lgkmcnt(0)
    v_mfma_f32_16x16x32_bf16 v[36:39], v[116:119], v[132:135], v[36:39]
    ds_read_b128 v[152:155], v3 offset:0
    v_mfma_f32_16x16x32_bf16 v[40:43], v[116:119], v[136:139], v[40:43]
    ds_read_b64_tr_b16 v[168:169], v10 offset:5120
    v_mfma_f32_16x16x32_bf16 v[44:47], v[116:119], v[140:143], v[44:47]
    ds_read_b64_tr_b16 v[170:171], v10 offset:6400
    v_mfma_f32_16x16x32_bf16 v[48:51], v[116:119], v[144:147], v[48:51]
    ds_read_b64_tr_b16 v[172:173], v10 offset:5152
    v_mfma_f32_16x16x32_bf16 v[52:55], v[116:119], v[148:151], v[52:55]
    ds_read_b64_tr_b16 v[174:175], v10 offset:6432
    v_mfma_f32_16x16x32_bf16 v[56:59], v[120:123], v[132:135], v[56:59]
    ds_read_b64_tr_b16 v[176:177], v11 offset:5120
    v_mfma_f32_16x16x32_bf16 v[60:63], v[120:123], v[136:139], v[60:63]
    ds_read_b64_tr_b16 v[178:179], v11 offset:6400
    v_mfma_f32_16x16x32_bf16 v[64:67], v[120:123], v[140:143], v[64:67]
    ds_read_b64_tr_b16 v[180:181], v10 offset:15392
    v_mfma_f32_16x16x32_bf16 v[68:71], v[120:123], v[144:147], v[68:71]
    ds_read_b64_tr_b16 v[182:183], v10 offset:16672
    v_mfma_f32_16x16x32_bf16 v[72:75], v[120:123], v[148:151], v[72:75]
    ds_read_b64_tr_b16 v[184:185], v10 offset:15424
    v_mfma_f32_16x16x32_bf16 v[76:79], v[124:127], v[132:135], v[76:79]
    ds_read_b64_tr_b16 v[186:187], v10 offset:16704
    v_mfma_f32_16x16x32_bf16 v[80:83], v[124:127], v[136:139], v[80:83]
    ds_read_b128 v[156:159], v3 offset:2048
    v_mfma_f32_16x16x32_bf16 v[84:87], v[124:127], v[140:143], v[84:87]
    ds_read_b128 v[160:163], v3 offset:4096
    v_mfma_f32_16x16x32_bf16 v[88:91], v[124:127], v[144:147], v[88:91]
    ds_read_b128 v[164:167], v3 offset:6144
    v_mfma_f32_16x16x32_bf16 v[92:95], v[124:127], v[148:151], v[92:95]
    v_mfma_f32_16x16x32_bf16 v[96:99], v[128:131], v[132:135], v[96:99]
    v_mfma_f32_16x16x32_bf16 v[100:103], v[128:131], v[136:139], v[100:103]
    v_mfma_f32_16x16x32_bf16 v[104:107], v[128:131], v[140:143], v[104:107]
    v_mfma_f32_16x16x32_bf16 v[108:111], v[128:131], v[144:147], v[108:111]
    v_mfma_f32_16x16x32_bf16 v[112:115], v[128:131], v[148:151], v[112:115]
    global_load_dword v21, v20, s[44:45] sc1
    s_waitcnt lgkmcnt(0)
    s_barrier
    s_setprio 3
    v_mfma_f32_16x16x32_bf16 v[36:39], v[152:155], v[168:171], v[36:39]
    v_mfma_f32_16x16x32_bf16 v[40:43], v[152:155], v[172:175], v[40:43]
    v_mfma_f32_16x16x32_bf16 v[44:47], v[152:155], v[176:179], v[44:47]
    v_mfma_f32_16x16x32_bf16 v[48:51], v[152:155], v[180:183], v[48:51]
    v_mfma_f32_16x16x32_bf16 v[52:55], v[152:155], v[184:187], v[52:55]
    v_mfma_f32_16x16x32_bf16 v[56:59], v[156:159], v[168:171], v[56:59]
    v_mfma_f32_16x16x32_bf16 v[60:63], v[156:159], v[172:175], v[60:63]
    v_mfma_f32_16x16x32_bf16 v[64:67], v[156:159], v[176:179], v[64:67]
    v_mfma_f32_16x16x32_bf16 v[68:71], v[156:159], v[180:183], v[68:71]
    v_fma_f32 v24, v36, v8, -v8
    v_fma_f32 v25, v37, v8, -v8
    v_mfma_f32_16x16x32_bf16 v[72:75], v[156:159], v[184:187], v[72:75]
    v_fma_f32 v26, v38, v8, -v8
    v_fma_f32 v27, v39, v8, -v8
    v_mfma_f32_16x16x32_bf16 v[76:79], v[160:163], v[168:171], v[76:79]
    v_fma_f32 v28, v40, v8, -v8
    v_fma_f32 v29, v41, v8, -v8
    v_mfma_f32_16x16x32_bf16 v[80:83], v[160:163], v[172:175], v[80:83]
    v_fma_f32 v30, v42, v8, -v8
    v_fma_f32 v31, v43, v8, -v8
    v_mfma_f32_16x16x32_bf16 v[84:87], v[160:163], v[176:179], v[84:87]
    v_fma_f32 v32, v44, v8, -v8
    v_fma_f32 v33, v45, v8, -v8
    v_mfma_f32_16x16x32_bf16 v[88:91], v[160:163], v[180:183], v[88:91]
    v_fma_f32 v34, v46, v8, -v8
    v_fma_f32 v35, v47, v8, -v8
    v_mfma_f32_16x16x32_bf16 v[92:95], v[160:163], v[184:187], v[92:95]
    v_exp_f32_e64 v24, v24 clamp
    v_mfma_f32_16x16x32_bf16 v[96:99], v[164:167], v[168:171], v[96:99]
    v_exp_f32_e64 v25, v25 clamp
    v_mfma_f32_16x16x32_bf16 v[100:103], v[164:167], v[172:175], v[100:103]
    v_exp_f32_e64 v26, v26 clamp
    v_mfma_f32_16x16x32_bf16 v[104:107], v[164:167], v[176:179], v[104:107]
    v_exp_f32_e64 v27, v27 clamp
    v_mfma_f32_16x16x32_bf16 v[108:111], v[164:167], v[180:183], v[108:111]
    v_exp_f32_e64 v28, v28 clamp
    v_mfma_f32_16x16x32_bf16 v[112:115], v[164:167], v[184:187], v[112:115]
    v_exp_f32_e64 v29, v29 clamp
    v_exp_f32_e64 v30, v30 clamp
    v_exp_f32_e64 v31, v31 clamp
    v_exp_f32_e64 v32, v32 clamp
    v_exp_f32_e64 v33, v33 clamp
    v_exp_f32_e64 v34, v34 clamp
    v_exp_f32_e64 v35, v35 clamp
    v_max_f32 v24, v24, v36
    v_max_f32 v25, v25, v37
    v_max_f32 v26, v26, v38
    v_max_f32 v27, v27, v39
    v_max_f32 v28, v28, v40
    v_max_f32 v29, v29, v41
    v_max_f32 v30, v30, v42
    v_max_f32 v31, v31, v43
    v_max_f32 v32, v32, v44
    v_max_f32 v33, v33, v45
    v_max_f32 v34, v34, v46
    v_max_f32 v35, v35, v47
    v_add_f32 v24, v24, v9
    v_add_f32 v25, v25, v9
    v_add_f32 v26, v26, v9
    v_add_f32 v27, v27, v9
    v_add_f32 v28, v28, v9
    v_add_f32 v29, v29, v9
    v_add_f32 v30, v30, v9
    v_add_f32 v31, v31, v9
    v_add_f32 v32, v32, v9
    v_add_f32 v33, v33, v9
    v_add_f32 v34, v34, v9
    v_add_f32 v35, v35, v9
    v_cndmask_b32 v32, v44, v32, s[10:11]
    v_cndmask_b32 v33, v45, v33, s[10:11]
    v_cndmask_b32 v34, v46, v34, s[10:11]
    v_cndmask_b32 v35, v47, v35, s[10:11]
    v_cvt_pk_bf16_f32 v208, v24, v25
    v_cvt_pk_bf16_f32 v209, v26, v27
    v_cvt_pk_bf16_f32 v216, v28, v29
    v_cvt_pk_bf16_f32 v217, v30, v31
    v_cvt_pk_bf16_f32 v224, v32, v33
    v_cvt_pk_bf16_f32 v225, v34, v35
    v_cvt_pk_bf16_f32 v232, v48, v49
    v_cvt_pk_bf16_f32 v233, v50, v51
    v_cvt_pk_bf16_f32 v240, v52, v53
    v_cvt_pk_bf16_f32 v241, v54, v55
    s_setprio 3
    s_nop 0
    v_pk_fma_f32 v[24:25], v[56:57], v[8:9], v[8:9] op_sel_hi:[1,0,0] neg_lo:[0,0,1] neg_hi:[0,0,1]
    v_pk_fma_f32 v[26:27], v[58:59], v[8:9], v[8:9] op_sel_hi:[1,0,0] neg_lo:[0,0,1] neg_hi:[0,0,1]
    v_pk_fma_f32 v[28:29], v[60:61], v[8:9], v[8:9] op_sel_hi:[1,0,0] neg_lo:[0,0,1] neg_hi:[0,0,1]
    v_pk_fma_f32 v[30:31], v[62:63], v[8:9], v[8:9] op_sel_hi:[1,0,0] neg_lo:[0,0,1] neg_hi:[0,0,1]
    v_pk_fma_f32 v[32:33], v[64:65], v[8:9], v[8:9] op_sel_hi:[1,0,0] neg_lo:[0,0,1] neg_hi:[0,0,1]
    v_pk_fma_f32 v[34:35], v[66:67], v[8:9], v[8:9] op_sel_hi:[1,0,0] neg_lo:[0,0,1] neg_hi:[0,0,1]
    v_exp_f32_e64 v24, v24 clamp
    v_exp_f32_e64 v25, v25 clamp
    v_exp_f32_e64 v26, v26 clamp
    v_exp_f32_e64 v27, v27 clamp
    v_exp_f32_e64 v28, v28 clamp
    v_exp_f32_e64 v29, v29 clamp
    v_exp_f32_e64 v30, v30 clamp
    v_exp_f32_e64 v31, v31 clamp
    v_exp_f32_e64 v32, v32 clamp
    v_exp_f32_e64 v33, v33 clamp
    v_exp_f32_e64 v34, v34 clamp
    v_exp_f32_e64 v35, v35 clamp
    v_max_f32 v24, v24, v56
    v_max_f32 v25, v25, v57
    v_max_f32 v26, v26, v58
    v_max_f32 v27, v27, v59
    v_max_f32 v28, v28, v60
    v_max_f32 v29, v29, v61
    v_max_f32 v30, v30, v62
    v_max_f32 v31, v31, v63
    v_max_f32 v32, v32, v64
    v_max_f32 v33, v33, v65
    v_max_f32 v34, v34, v66
    v_max_f32 v35, v35, v67
    v_pk_add_f32 v[24:25], v[24:25], v[8:9] op_sel:[0,1] op_sel_hi:[1,1]
    v_pk_add_f32 v[26:27], v[26:27], v[8:9] op_sel:[0,1] op_sel_hi:[1,1]
    v_pk_add_f32 v[28:29], v[28:29], v[8:9] op_sel:[0,1] op_sel_hi:[1,1]
    v_pk_add_f32 v[30:31], v[30:31], v[8:9] op_sel:[0,1] op_sel_hi:[1,1]
    v_pk_add_f32 v[32:33], v[32:33], v[8:9] op_sel:[0,1] op_sel_hi:[1,1]
    v_pk_add_f32 v[34:35], v[34:35], v[8:9] op_sel:[0,1] op_sel_hi:[1,1]
    v_cndmask_b32 v32, v64, v32, s[10:11]
    v_cndmask_b32 v33, v65, v33, s[10:11]
    v_cndmask_b32 v34, v66, v34, s[10:11]
    v_cndmask_b32 v35, v67, v35, s[10:11]
    v_cvt_pk_bf16_f32 v210, v24, v25
    v_cvt_pk_bf16_f32 v211, v26, v27
    v_cvt_pk_bf16_f32 v218, v28, v29
    v_cvt_pk_bf16_f32 v219, v30, v31
    v_cvt_pk_bf16_f32 v226, v32, v33
    v_cvt_pk_bf16_f32 v227, v34, v35
    v_cvt_pk_bf16_f32 v234, v68, v69
    v_cvt_pk_bf16_f32 v235, v70, v71
    v_cvt_pk_bf16_f32 v242, v72, v73
    v_cvt_pk_bf16_f32 v243, v74, v75
    v_pk_fma_f32 v[24:25], v[76:77], v[8:9], v[8:9] op_sel_hi:[1,0,0] neg_lo:[0,0,1] neg_hi:[0,0,1]
    v_pk_fma_f32 v[26:27], v[78:79], v[8:9], v[8:9] op_sel_hi:[1,0,0] neg_lo:[0,0,1] neg_hi:[0,0,1]
    v_pk_fma_f32 v[28:29], v[80:81], v[8:9], v[8:9] op_sel_hi:[1,0,0] neg_lo:[0,0,1] neg_hi:[0,0,1]
    v_pk_fma_f32 v[30:31], v[82:83], v[8:9], v[8:9] op_sel_hi:[1,0,0] neg_lo:[0,0,1] neg_hi:[0,0,1]
    v_pk_fma_f32 v[32:33], v[84:85], v[8:9], v[8:9] op_sel_hi:[1,0,0] neg_lo:[0,0,1] neg_hi:[0,0,1]
    v_pk_fma_f32 v[34:35], v[86:87], v[8:9], v[8:9] op_sel_hi:[1,0,0] neg_lo:[0,0,1] neg_hi:[0,0,1]
    v_mfma_f32_16x16x32_bf16 v[36:39], v[224:227], v[208:211], 0
    v_exp_f32_e64 v24, v24 clamp
    v_exp_f32_e64 v25, v25 clamp
    v_mfma_f32_16x16x32_bf16 v[40:43], v[232:235], v[208:211], 0
    v_exp_f32_e64 v26, v26 clamp
    v_exp_f32_e64 v27, v27 clamp
    v_mfma_f32_16x16x32_bf16 v[44:47], v[224:227], v[216:219], 0
    v_exp_f32_e64 v28, v28 clamp
    v_exp_f32_e64 v29, v29 clamp
    v_mfma_f32_16x16x32_bf16 v[48:51], v[232:235], v[216:219], 0
    v_exp_f32_e64 v30, v30 clamp
    v_exp_f32_e64 v31, v31 clamp
    v_mfma_f32_16x16x32_bf16 v[52:55], v[240:243], v[216:219], 0
    v_exp_f32_e64 v32, v32 clamp
    v_exp_f32_e64 v33, v33 clamp
    v_mfma_f32_16x16x32_bf16 v[56:59], v[232:235], v[224:227], 0
    v_exp_f32_e64 v34, v34 clamp
    v_exp_f32_e64 v35, v35 clamp
    v_mfma_f32_16x16x32_bf16 v[60:63], v[240:243], v[224:227], 0
    v_max_f32 v24, v24, v76
    v_max_f32 v25, v25, v77
    v_max_f32 v26, v26, v78
    v_mfma_f32_16x16x32_bf16 v[64:67], v[4:7], v[208:211], 0
    v_max_f32 v27, v27, v79
    v_max_f32 v28, v28, v80
    v_max_f32 v29, v29, v81
    v_mfma_f32_16x16x32_bf16 v[68:71], v[4:7], v[216:219], 0
    v_max_f32 v30, v30, v82
    v_max_f32 v31, v31, v83
    v_max_f32 v32, v32, v84
    v_mfma_f32_16x16x32_bf16 v[72:75], v[4:7], v[224:227], 0
    v_max_f32 v33, v33, v85
    v_max_f32 v34, v34, v86
    v_max_f32 v35, v35, v87
    v_pk_add_f32 v[24:25], v[24:25], v[8:9] op_sel:[0,1] op_sel_hi:[1,1]
    v_pk_add_f32 v[26:27], v[26:27], v[8:9] op_sel:[0,1] op_sel_hi:[1,1]
    v_pk_add_f32 v[28:29], v[28:29], v[8:9] op_sel:[0,1] op_sel_hi:[1,1]
    v_pk_add_f32 v[30:31], v[30:31], v[8:9] op_sel:[0,1] op_sel_hi:[1,1]
    v_pk_add_f32 v[32:33], v[32:33], v[8:9] op_sel:[0,1] op_sel_hi:[1,1]
    v_pk_add_f32 v[34:35], v[34:35], v[8:9] op_sel:[0,1] op_sel_hi:[1,1]
    v_cndmask_b32 v32, v84, v32, s[10:11]
    v_cndmask_b32 v33, v85, v33, s[10:11]
    v_cndmask_b32 v34, v86, v34, s[10:11]
    v_cndmask_b32 v35, v87, v35, s[10:11]
    v_cvt_pk_bf16_f32 v212, v24, v25
    v_cvt_pk_bf16_f32 v213, v26, v27
    v_cvt_pk_bf16_f32 v220, v28, v29
    v_cvt_pk_bf16_f32 v221, v30, v31
    v_cvt_pk_bf16_f32 v228, v32, v33
    v_cvt_pk_bf16_f32 v229, v34, v35
    v_cvt_pk_bf16_f32 v236, v88, v89
    v_cvt_pk_bf16_f32 v237, v90, v91
    v_cvt_pk_bf16_f32 v244, v92, v93
    v_cvt_pk_bf16_f32 v245, v94, v95
    v_pk_fma_f32 v[24:25], v[96:97], v[8:9], v[8:9] op_sel_hi:[1,0,0] neg_lo:[0,0,1] neg_hi:[0,0,1]
    v_pk_fma_f32 v[26:27], v[98:99], v[8:9], v[8:9] op_sel_hi:[1,0,0] neg_lo:[0,0,1] neg_hi:[0,0,1]
    v_pk_fma_f32 v[28:29], v[100:101], v[8:9], v[8:9] op_sel_hi:[1,0,0] neg_lo:[0,0,1] neg_hi:[0,0,1]
    v_pk_fma_f32 v[30:31], v[102:103], v[8:9], v[8:9] op_sel_hi:[1,0,0] neg_lo:[0,0,1] neg_hi:[0,0,1]
    v_pk_fma_f32 v[32:33], v[104:105], v[8:9], v[8:9] op_sel_hi:[1,0,0] neg_lo:[0,0,1] neg_hi:[0,0,1]
    v_pk_fma_f32 v[34:35], v[106:107], v[8:9], v[8:9] op_sel_hi:[1,0,0] neg_lo:[0,0,1] neg_hi:[0,0,1]
    v_exp_f32_e64 v24, v24 clamp
    v_exp_f32_e64 v25, v25 clamp
    v_exp_f32_e64 v26, v26 clamp
    v_exp_f32_e64 v27, v27 clamp
    v_exp_f32_e64 v28, v28 clamp
    v_exp_f32_e64 v29, v29 clamp
    v_exp_f32_e64 v30, v30 clamp
    v_exp_f32_e64 v31, v31 clamp
    v_exp_f32_e64 v32, v32 clamp
    v_exp_f32_e64 v33, v33 clamp
    v_exp_f32_e64 v34, v34 clamp
    v_exp_f32_e64 v35, v35 clamp
    v_max_f32 v24, v24, v96
    v_max_f32 v25, v25, v97
    v_max_f32 v26, v26, v98
    v_max_f32 v27, v27, v99
    v_max_f32 v28, v28, v100
    v_max_f32 v29, v29, v101
    v_max_f32 v30, v30, v102
    v_max_f32 v31, v31, v103
    v_max_f32 v32, v32, v104
    v_max_f32 v33, v33, v105
    v_max_f32 v34, v34, v106
    v_max_f32 v35, v35, v107
    v_pk_add_f32 v[24:25], v[24:25], v[8:9] op_sel:[0,1] op_sel_hi:[1,1]
    v_pk_add_f32 v[26:27], v[26:27], v[8:9] op_sel:[0,1] op_sel_hi:[1,1]
    v_pk_add_f32 v[28:29], v[28:29], v[8:9] op_sel:[0,1] op_sel_hi:[1,1]
    v_pk_add_f32 v[30:31], v[30:31], v[8:9] op_sel:[0,1] op_sel_hi:[1,1]
    v_pk_add_f32 v[32:33], v[32:33], v[8:9] op_sel:[0,1] op_sel_hi:[1,1]
    v_pk_add_f32 v[34:35], v[34:35], v[8:9] op_sel:[0,1] op_sel_hi:[1,1]
    v_cndmask_b32 v32, v104, v32, s[10:11]
    v_cndmask_b32 v33, v105, v33, s[10:11]
    v_cndmask_b32 v34, v106, v34, s[10:11]
    v_cndmask_b32 v35, v107, v35, s[10:11]
    v_cvt_pk_bf16_f32 v214, v24, v25
    v_cvt_pk_bf16_f32 v215, v26, v27
    v_cvt_pk_bf16_f32 v222, v28, v29
    v_cvt_pk_bf16_f32 v223, v30, v31
    v_cvt_pk_bf16_f32 v230, v32, v33
    v_cvt_pk_bf16_f32 v231, v34, v35
    v_cvt_pk_bf16_f32 v238, v108, v109
    v_cvt_pk_bf16_f32 v239, v110, v111
    v_cvt_pk_bf16_f32 v246, v112, v113
    v_cvt_pk_bf16_f32 v247, v114, v115
    v_mfma_f32_16x16x32_bf16 v[36:39], v[228:231], v[212:215], v[36:39]
    v_mfma_f32_16x16x32_bf16 v[40:43], v[236:239], v[212:215], v[40:43]
    v_mfma_f32_16x16x32_bf16 v[44:47], v[228:231], v[220:223], v[44:47]
    v_mfma_f32_16x16x32_bf16 v[48:51], v[236:239], v[220:223], v[48:51]
    v_mfma_f32_16x16x32_bf16 v[52:55], v[244:247], v[220:223], v[52:55]
    v_mfma_f32_16x16x32_bf16 v[56:59], v[236:239], v[228:231], v[56:59]
    v_mfma_f32_16x16x32_bf16 v[60:63], v[244:247], v[228:231], v[60:63]
    v_mfma_f32_16x16x32_bf16 v[64:67], v[4:7], v[212:215], v[64:67]
    v_mfma_f32_16x16x32_bf16 v[68:71], v[4:7], v[220:223], v[68:71]
    v_mfma_f32_16x16x32_bf16 v[72:75], v[4:7], v[228:231], v[72:75]
    s_lshl_b32 m0, s60, 8
    s_mul_i32 s8, s62, 6720
    s_add_u32 s48, s46, s8
    s_addc_u32 s49, s47, 0
    s_mov_b32 s50, 6720
    s_mov_b32 s51, 0x20000
    ds_write_addtid_b32 v36 offset:0
    ds_write_addtid_b32 v37 offset:1040
    ds_write_addtid_b32 v38 offset:2080
    ds_write_addtid_b32 v39 offset:3120
    ds_write_addtid_b32 v40 offset:4160
    ds_write_addtid_b32 v41 offset:5200
    ds_write_addtid_b32 v42 offset:6240
    ds_write_addtid_b32 v43 offset:7280
    ds_write_addtid_b32 v44 offset:8320
    ds_write_addtid_b32 v45 offset:9360
    ds_write_addtid_b32 v46 offset:10400
    ds_write_addtid_b32 v47 offset:11440
    ds_write_addtid_b32 v48 offset:12480
    ds_write_addtid_b32 v49 offset:13520
    ds_write_addtid_b32 v50 offset:14560
    ds_write_addtid_b32 v51 offset:15600
    ds_write_addtid_b32 v52 offset:16640
    ds_write_addtid_b32 v53 offset:17680
    ds_write_addtid_b32 v54 offset:18720
    ds_write_addtid_b32 v55 offset:19760
    ds_write_addtid_b32 v56 offset:20800
    ds_write_addtid_b32 v57 offset:21840
    ds_write_addtid_b32 v58 offset:22880
    ds_write_addtid_b32 v59 offset:23920
    ds_write_addtid_b32 v60 offset:24960
    ds_write_addtid_b32 v61 offset:26000
    ds_write_addtid_b32 v62 offset:27040
    ds_write_addtid_b32 v63 offset:28080
    ds_write_addtid_b32 v64 offset:29120
    ds_write_addtid_b32 v68 offset:30160
    ds_write_addtid_b32 v72 offset:31200
    v_and_b32 v97, 31, v1
    s_lshl_b32 s8, s60, 7
    v_lshl_add_u32 v97, v97, 2, s8
    s_lshl_b32 s4, s61, 9
    s_add_u32 s4, s4, 81920
    v_add_u32 v98, s4, v97
    s_mov_b32 s13, 32768
Lfl_23:
    s_waitcnt vmcnt(0)
    v_cmp_eq_u32 vcc, 0, v21
    s_cbranch_vccz Lfo_24
    global_load_dword v21, v20, s[44:45] sc1
    s_sub_u32 s13, s13, 1
    s_cmp_lg_u32 s13, 0
    s_cbranch_scc1 Lfl_23
Lfo_24:
    s_setprio 3
    s_waitcnt lgkmcnt(0)
    s_barrier
    ds_read_b32 v96, v97 offset:45056
    ds_read2_b32 v[80:81], v12 offset0:0 offset1:128
    ds_read2_b32 v[82:83], v13 offset0:0 offset1:128
    ds_read2_b32 v[84:85], v14 offset0:0 offset1:128
    ds_read2_b32 v[86:87], v15 offset0:0 offset1:128
    ds_read2_b32 v[88:89], v16 offset0:0 offset1:128
    ds_read2_b32 v[90:91], v17 offset0:0 offset1:128
    ds_read2_b32 v[92:93], v18 offset0:0 offset1:128
    s_waitcnt lgkmcnt(6)
    v_add_f32 v80, v80, v81
    buffer_atomic_add_f32 v80, v192, s[48:51], 0 offen
    s_waitcnt lgkmcnt(5)
    v_add_f32 v82, v82, v83
    buffer_atomic_add_f32 v82, v193, s[48:51], 0 offen
    s_waitcnt lgkmcnt(4)
    v_add_f32 v84, v84, v85
    buffer_atomic_add_f32 v84, v194, s[48:51], 0 offen
    s_waitcnt lgkmcnt(3)
    v_add_f32 v86, v86, v87
    buffer_atomic_add_f32 v86, v195, s[48:51], 0 offen
    s_waitcnt lgkmcnt(2)
    v_add_f32 v88, v88, v89
    buffer_atomic_add_f32 v88, v196, s[48:51], 0 offen
    s_waitcnt lgkmcnt(1)
    v_add_f32 v90, v90, v91
    buffer_atomic_add_f32 v90, v197, s[48:51], 0 offen
    s_waitcnt lgkmcnt(0)
    v_add_f32 v92, v92, v93
    buffer_atomic_add_f32 v92, v198, s[48:51], 0 offen
    s_mov_b32 exec_hi, 0
    global_atomic_add_f32 v98, v96, s[46:47]
    s_mov_b32 exec_hi, -1
    s_and_b32 s14, s61, 3
    s_lshl_b32 s14, s14, 2
    s_add_u32 s6, s14, 67328
    s_and_b32 s15, s2, 6
    s_lshl_b32 s15, 0x03030303, s15
    s_and_b32 s8, s62, 3
    s_lshl_b32 s8, s8, 3
    s_lshr_b32 s9, s62, 2
    s_add_u32 s8, s8, s9
    s_lshl_b32 s8, 0x55, s8
    s_mov_b32 s7, 3
    s_mov_b32 s9, 132608
    v_mov_b32 v24, 163828
    v_mov_b32 v25, 1
    v_lshl_add_u32 v27, v1, 11, s9
    s_mov_b32 exec_lo, 0
    v_lshl_add_u32 v27, v1, 11, s6
    s_mov_b32 exec_lo, -1
    s_waitcnt vmcnt(0)
    s_cmp_eq_u32 s7, 0
    s_cbranch_scc1 Lsg_25
    s_mov_b64 exec, 1
    ds_add_rtn_u32 v26, v24, v25
    s_waitcnt lgkmcnt(0)
    v_cmp_eq_u32 vcc, s7, v26
    s_cbranch_vccz Lsg_25
    s_mov_b32 exec_lo, s8
    s_mov_b32 exec_hi, s15
    global_atomic_add v27, v25, s[46:47] sc1
Lsg_25:
    s_mov_b64 exec, -1
    s_cmp_lg_u32 s60, 0
    s_cbranch_scc1 Lg_nk_26
    s_and_b32 s7, s2, 31
    s_lshl_b32 s7, s7, 11
    s_add_u32 s7, s7, 132608
    v_mov_b32_e64 v24, s7
    s_add_u32 s7, s7, s14
    s_add_u32 s7, s7, 256
    v_writelane_b32 v24, s7, 1
    v_mov_b32 v27, 0
    s_mov_b64 exec, 3
    global_atomic_add v25, v24, v27, s[46:47] sc0 sc1
    s_mov_b64 exec, -1
    v_mov_b32 v34, 16
    v_writelane_b32 v34, 8, 1
    v_lshlrev_b32 v28, 4, v1
    v_add_u32 v29, 4096, v28
    v_lshlrev_b32 v30, 3, v1
    v_add_u32 v31, s4, v30
    ds_read_b32 v33, v30
    s_waitcnt lgkmcnt(0)
    ds_read_b32 v33, v30
    s_waitcnt lgkmcnt(0)
    ds_read_b32 v33, v30
    s_waitcnt lgkmcnt(0)
    s_mov_b32 s13, 32768
    s_mov_b64 exec, 3
Lp2_28:
    global_atomic_add v26, v24, v27, s[46:47] sc0 sc1
    s_waitcnt vmcnt(1)
    v_cmp_ne_u32 vcc, v34, v25
    s_nop 0
    s_and_b32 s12, vcc_lo, 3
    s_cbranch_scc0 Lp2e_29
    global_atomic_add v25, v24, v27, s[46:47] sc0 sc1
    s_sub_u32 s13, s13, 1
    s_cselect_b32 s12, 0, 3
    s_waitcnt vmcnt(1)
    v_cmp_ne_u32 vcc, v34, v26
    s_nop 0
    s_and_b32 s12, s12, vcc_lo
    s_cbranch_scc1 Lp2_28
Lp2e_29:
    s_mov_b64 exec, -1
    global_load_dwordx2 v[110:111], v31, s[46:47] sc1
    buffer_load_dwordx4 v[80:83], v28, s[48:51], 0 offen offset:0 sc1
    buffer_load_dwordx4 v[84:87], v28, s[48:51], 0 offen offset:1024 sc1
    buffer_load_dwordx4 v[88:91], v28, s[48:51], 0 offen offset:2048 sc1
    buffer_load_dwordx4 v[92:95], v28, s[48:51], 0 offen offset:3072 sc1
    buffer_load_dwordx4 v[96:99], v29, s[48:51], 0 offen offset:0 sc1
    buffer_load_dwordx4 v[100:103], v29, s[48:51], 0 offen offset:1024 sc1
    buffer_load_dwordx4 v[104:107], v29, s[48:51], 0 offen offset:2048 sc1
    s_waitcnt vmcnt(7)
    ds_write_b64 v30, v[110:111] offset:45056
    s_waitcnt vmcnt(6)
    v_cvt_pk_bf16_f32 v80, v80, v81
    v_cvt_pk_bf16_f32 v81, v82, v83
    ds_write_b64 v30, v[80:81] offset:40960
    s_waitcnt vmcnt(5)
    v_cvt_pk_bf16_f32 v84, v84, v85
    v_cvt_pk_bf16_f32 v85, v86, v87
    ds_write_b64 v30, v[84:85] offset:41472
    s_waitcnt vmcnt(4)
    v_cvt_pk_bf16_f32 v88, v88, v89
    v_cvt_pk_bf16_f32 v89, v90, v91
    ds_write_b64 v30, v[88:89] offset:41984
    s_waitcnt vmcnt(3)
    v_cvt_pk_bf16_f32 v92, v92, v93
    v_cvt_pk_bf16_f32 v93, v94, v95
    ds_write_b64 v30, v[92:93] offset:42496
    s_waitcnt vmcnt(2)
    v_cvt_pk_bf16_f32 v96, v96, v97
    v_cvt_pk_bf16_f32 v97, v98, v99
    ds_write_b64 v30, v[96:97] offset:43008
    s_waitcnt vmcnt(1)
    v_cvt_pk_bf16_f32 v100, v100, v101
    v_cvt_pk_bf16_f32 v101, v102, v103
    ds_write_b64 v30, v[100:101] offset:43520
    s_waitcnt vmcnt(0)
    v_cvt_pk_bf16_f32 v104, v104, v105
    v_cvt_pk_bf16_f32 v105, v106, v107
    ds_write_b64 v30, v[104:105] offset:44032
    v_mov_b32 v24, 163824
    v_mov_b32 v25, 0x1000000
    s_waitcnt lgkmcnt(0)
    s_mov_b64 exec, 1
    ds_add_u32 v24, v25
    s_mov_b64 exec, -1
    s_branch Lg_kd_27
Lg_nk_26:
    s_cmp_gt_u32 s60, 3
    s_cbranch_scc1 Lg_kd_27
    s_setprio 0
    s_sub_u32 s7, s60, 1
    v_mul_u32_u24 v22, 26, v1
    v_lshrrev_b32 v22, 8, v22
    v_mul_u32_u24 v22, 1120, v22
    v_lshl_add_u32 v22, v1, 4, v22
    s_mul_i32 s8, s7, 7680
    s_mul_i32 s9, s62, 160
    s_add_u32 s8, s8, s9
    v_add_u32 v22, s8, v22
    s_mov_b32 s52, s38
    s_mov_b32 s53, s39
    s_mov_b32 s54, 819200
    s_mov_b32 s55, 0x20000
    s_mul_i32 s56, s7, 960
    s_add_u32 s56, s56, 51200
    v_mov_b32 v32, 163824
    s_mov_b32 s57, 0
    s_add_u32 s58, s56, 0
Lg_wo_30:
    s_mov_b32 m0, s58
    s_add_u32 s58, s58, 2880
    buffer_load_dwordx4 v22, s[52:55], s57 offen lds
    s_add_u32 s57, s57, 23040
    s_cmp_lg_u32 s57, 69120
    s_cbranch_scc1 Lg_wo_30
Lg_qw_31:
    ds_read_b32 v33, v32
    s_waitcnt lgkmcnt(0)
    v_and_b32 v33, 65535, v33
    v_cmp_gt_u32_e64 vcc, 4, v33
    s_cbranch_vccnz Lg_qw_31
    s_mov_b32 s57, 506880
    s_add_u32 s58, s56, 63360
Lg_wo_32:
    s_mov_b32 m0, s58
    s_add_u32 s58, s58, 2880
    buffer_load_dwordx4 v22, s[52:55], s57 offen lds
    s_add_u32 s57, s57, 23040
    s_cmp_lg_u32 s57, 829440
    s_cbranch_scc1 Lg_wo_32
Lg_qw_33:
    ds_read_b32 v33, v32
    s_waitcnt lgkmcnt(0)
    v_and_b32 v33, 16777215, v33
    v_cmp_gt_u32 vcc, 262144, v33
    s_cbranch_vccnz Lg_qw_33
    s_mov_b32 s57, 69120
    s_add_u32 s58, s56, 8640
Lg_wo_34:
    s_mov_b32 m0, s58
    s_add_u32 s58, s58, 2880
    buffer_load_dwordx4 v22, s[52:55], s57 offen lds
    s_add_u32 s57, s57, 23040
    s_cmp_lg_u32 s57, 506880
    s_cbranch_scc1 Lg_wo_34
    s_mov_b32 s57, 483840
    s_add_u32 s58, s56, 60480
Lg_wo_35:
    s_mov_b32 m0, s58
    s_add_u32 s58, s58, 2880
    buffer_load_dwordx4 v22, s[52:55], s57 offen lds
    s_add_u32 s57, s57, 23040
    s_cmp_lg_u32 s57, 506880
    s_cbranch_scc1 Lg_wo_35
    v_mov_b32 v32, 163820
    v_mov_b32 v33, 1
    s_mov_b64 exec, 1
    ds_add_u32 v32, v33
    s_mov_b64 exec, -1
Lg_kd_27:
    s_setprio 0
    s_mov_b32 s56, 0
Lg_end_6:
    s_and_b32 s57, s61, 3
    s_lshl_b32 s57, s57, 8
    s_add_u32 s57, s57, 131072
    s_and_b32 s58, s2, 6
    s_lshl_b32 s58, 0x03030303, s58
    s_mov_b32 s59, 0
    s_branch L_p2
L_s:
    s_getpc_b64 s[64:65]
Ls_pc_36:
    s_lshr_b32 s49, s61, 4
    v_mul_u32_u24 v64, 2560, v65
    s_mul_i32 s13, s48, 46080
    s_add_u32 s13, s13, s15
    v_add3_u32 v33, v66, v64, s13
    s_mul_i32 s50, s50, 640
    v_and_b32 v64, 31, v1
    v_mul_u32_u24 v64, 1280, v64
    v_lshrrev_b32 v65, 5, v1
    v_lshl_add_u32 v64, v65, 7, v64
    s_and_b32 s12, s2, 6
    s_lshl_b32 s12, s12, 3
    s_add_u32 s12, s12, s48
    s_mul_i32 s51, s12, 40960
    s_add_u32 s12, s51, s50
    v_add_u32 v38, s12, v64
    v_mov_b32 v10, 0
    v_mov_b32 v11, 0
    v_mov_b32 v12, 0
    v_mov_b32 v13, 0
    v_mov_b32 v14, 0
    v_mov_b32 v15, 0
    v_mov_b32 v16, 0
    v_mov_b32 v17, 0
    v_mov_b32 v48, 0
    v_mov_b32 v49, 0
    v_mov_b32 v50, 0
    v_mov_b32 v51, 0
    v_mov_b32 v52, 0
    v_mov_b32 v53, 0
    v_mov_b32 v54, 0
    v_mov_b32 v55, 0
    v_mov_b32 v56, 0
    v_mov_b32 v57, 0
    v_mov_b32 v58, 0
    v_mov_b32 v59, 0
    v_mov_b32 v60, 0
    v_mov_b32 v61, 0
    v_mov_b32 v62, 0
    v_mov_b32 v63, 0
    s_add_u32 s7, s7, 0x5556
    s_lshr_b32 s7, s7, 16
    s_min_u32 s7, s7, 4
    s_lshl_b32 s9, s7, 1
    s_add_u32 s9, s9, s8
    v_mov_b32_e64 v44, s9
    v_add_u32 v42, 128, v42
    s_lshr_b32 s10, 0x92, s60
    s_and_b32 s10, s10, 1
    s_mul_i32 s13, s48, 51200
    s_add_u32 s13, s13, s50
    v_add_u32 v39, s13, v66
    s_lshl_b32 s9, s50, 1
    s_sub_u32 s9, 640, s9
    v_add_u32 v38, s9, v38
    v_mov_b32 v46, 0
    v_mov_b32 v47, 163820
    ds_write2_b32 v47, v46, v46 offset0:0 offset1:4
    v_and_b32 v46, 31, v1
    v_lshrrev_b32 v47, 5, v1
    v_mad_u32_u24 v9, v47, 33, v46
    v_mul_u32_u24 v46, 2064, v46
    v_lshl_add_u32 v46, v47, 4, v46
    v_add_u32_e64 v40, s5, v46
    s_mul_i32 s9, s61, 80
    s_add_u32 s9, s9, 10485760
    v_add_u32_e64 v64, 0, v0
    v_min_u32 v64, 1279, v64
    v_mul_u32_u24 v65, 13108, v64
    v_lshrrev_b32_e64 v65, 16, v65
    v_mul_u32_u24 v67, 10160, v65
    v_lshl_add_u32 v67, v64, 4, v67
    v_add_u32 v24, s9, v67
    v_mul_u32_u24 v67, 5, v65
    v_sub_u32_e64 v64, v64, v67
    v_mul_u32_u24 v64, 4640, v64
    v_lshl_add_u32 v64, v65, 4, v64
    v_add_u32 v27, 93920, v64
    v_add_u32 v64, 512, v0
    v_min_u32 v64, 1279, v64
    v_mul_u32_u24 v65, 13108, v64
    v_lshrrev_b32_e64 v65, 16, v65
    v_mul_u32_u24 v67, 10160, v65
    v_lshl_add_u32 v67, v64, 4, v67
    v_add_u32 v25, s9, v67
    v_mul_u32_u24 v67, 5, v65
    v_sub_u32_e64 v64, v64, v67
    v_mul_u32_u24 v64, 4640, v64
    v_lshl_add_u32 v64, v65, 4, v64
    v_add_u32 v28, 93920, v64
    v_add_u32 v64, 1024, v0
    v_min_u32 v64, 1279, v64
    v_mul_u32_u24 v65, 13108, v64
    v_lshrrev_b32_e64 v65, 16, v65
    v_mul_u32_u24 v67, 10160, v65
    v_lshl_add_u32 v67, v64, 4, v67
    v_add_u32 v26, s9, v67
    v_mul_u32_u24 v67, 5, v65
    v_sub_u32_e64 v64, v64, v67
    v_mul_u32_u24 v64, 4640, v64
    v_lshl_add_u32 v64, v65, 4, v64
    v_add_u32 v29, 93920, v64
    v_and_b32 v30, 7, v1
    v_lshlrev_b32 v31, 13, v30
    v_add_u32 v31, 132352, v31
    v_lshlrev_b32 v30, 2, v30
    s_lshl_b32 s9, s49, 13
    s_add_u32 s9, s9, 132352
    v_mov_b32 v20, s9
    s_mov_b32 s56, 0
    s_add_u32 s57, s5, 49536
    v_lshrrev_b32_e64 v64, 4, v1
    v_bfe_u32 v65, v1, 2, 2
    v_lshl_add_u32 v65, v64, 3, v65
    v_and_b32 v67, 3, v1
    v_lshlrev_b32 v67, 3, v67
    v_lshl_add_u32 v65, v65, 7, v67
    v_add_u32 v22, 143328, v65
    v_mul_u32_u24 v64, 10240, v64
    v_and_b32 v67, 15, v1
    v_lshl_add_u32 v64, v67, 4, v64
    s_lshl_b32 s9, s50, 3
    s_add_u32 s9, s9, s51
    s_add_u32 s9, s9, 10487808
    v_add_u32_e64 v19, s9, v64
    s_mov_b32 m0, s57
    v_mov_b32 v46, 0x3f80
    ds_write_addtid_b32 v46
    s_cmp_eq_u32 s60, 7
    s_cbranch_scc1 Ls_slab_37
    global_load_short_d16_hi v16, v44, s[30:31]
    global_load_short_d16_hi v14, v42, s[18:19]
    global_load_short_d16_hi v15, v42, s[20:21]
    global_load_short_d16_hi v10, v42, s[22:23]
    global_load_short_d16_hi v11, v42, s[24:25]
    global_load_short_d16_hi v12, v42, s[26:27]
    global_load_short_d16_hi v13, v42, s[28:29]
    global_load_short_d16_hi v17, v43, s[32:33]
    s_waitcnt vmcnt(8)
Ls_slab_37:
    s_waitcnt vmcnt(20)
    v_mul_f32 v134, 0x3fb8aa3b, v8
    v_exp_f32 v134, v134
    v_mul_f32 v140, v4, v2
    v_mul_f32_e64 v141, v4, v3
    v_cvt_pk_bf16_f32 v134, v134, v134
    v_fma_f32 v140, -v5, v3, v140
    v_and_b32 v134, 0xffff0000, v134
    v_fmac_f32 v141, v5, v2
    v_mul_f32 v6, v134, v6
    v_mul_f32 v7, v134, v7
    v_mul_f32 v136, v134, v140
    v_mul_f32 v137, v134, v141
    v_mul_f32 v6, 0x3fb8aa3b, v6
    v_mul_f32 v7, 0.15915494, v7
    v_exp_f32 v140, v6
    v_rndne_f32 v142, v7
    v_sub_f32 v7, v7, v142
    v_cos_f32 v128, v7
    v_sin_f32_e64 v129, v7
    v_mul_f32 v6, 0x43800000, v6
    v_mul_f32 v7, 0x43800000, v7
    v_mul_f32 v128, v128, v140
    v_mul_f32 v129, v129, v140
    v_exp_f32 v142, v6
    v_cos_f32 v132, v7
    v_sin_f32 v133, v7
    v_mul_f32 v130, v128, v128
    v_mul_f32 v131, v128, v129
    v_fma_f32 v130, -v129, v129, v130
    v_add_f32 v131, v131, v131
    v_mul_f32 v132, v132, v142
    v_mul_f32 v133, v133, v142
    v_mul_f32 v140, v130, v130
    v_mul_f32 v141, v130, v131
    v_fma_f32 v140, -v131, v131, v140
    v_add_f32 v141, v141, v141
    v_mul_f32 v130, v140, v140
    v_mul_f32 v131, v140, v141
    v_fma_f32 v130, -v141, v141, v130
    v_add_f32 v131, v131, v131
    s_cmp_lg_u32 s60, 7
    s_cbranch_scc1 Ls_kgen_39
    s_cmp_lg_u32 s14, 0
    s_cbranch_scc1 Ls_nf_40
    v_mov_b32 v21, 1
    s_lshl_b64 exec, 1, s49
    global_store_dword v30, v21, s[44:45] sc1
    s_mov_b64 exec, -1
Ls_nf_40:
    v_add_u32 v37, 368640, v37
    v_subrev_u32 v254, 2457600, v37
    v_min_u32 v37, v37, v254
    global_load_dword v255, v37, s[36:37]
    v_add_u32 v37, 368640, v37
    v_subrev_u32 v254, 2457600, v37
    v_min_u32_e64 v37, v37, v254
    global_load_dword v255, v37, s[36:37]
    global_load_dword v255, v38, s[16:17] offset:0
    s_waitcnt vmcnt(3)
    ds_read_b64_tr_b16 v[64:65], v22 offset:0
    ds_read_b64_tr_b16 v[66:67], v22 offset:512
    ds_read_b64_tr_b16 v[68:69], v22 offset:32
    ds_read_b64_tr_b16 v[70:71], v22 offset:544
    ds_read_b64_tr_b16 v[72:73], v22 offset:64
    ds_read_b64_tr_b16 v[74:75], v22 offset:576
    ds_read_b64_tr_b16 v[76:77], v22 offset:96
    ds_read_b64_tr_b16 v[78:79], v22 offset:608
    ds_read_b64_tr_b16 v[80:81], v22 offset:4096
    ds_read_b64_tr_b16 v[82:83], v22 offset:4608
    ds_read_b64_tr_b16 v[84:85], v22 offset:4128
    ds_read_b64_tr_b16 v[86:87], v22 offset:4640
    ds_read_b64_tr_b16 v[88:89], v22 offset:4160
    ds_read_b64_tr_b16 v[90:91], v22 offset:4672
    s_waitcnt lgkmcnt(12)
    global_store_dwordx4 v19, v[64:67], s[46:47] offset:-2048 sc1
    ds_read_b64_tr_b16 v[92:93], v22 offset:4192
    ds_read_b64_tr_b16 v[94:95], v22 offset:4704
    s_waitcnt lgkmcnt(12)
    global_store_dwordx4 v19, v[68:71], s[46:47] offset:-1792 sc1
    ds_read_b64_tr_b16 v[96:97], v22 offset:8192
    ds_read_b64_tr_b16 v[98:99], v22 offset:8704
    s_waitcnt lgkmcnt(12)
    global_store_dwordx4 v19, v[72:75], s[46:47] offset:-1536 sc1
    ds_read_b64_tr_b16 v[100:101], v22 offset:8224
    ds_read_b64_tr_b16 v[102:103], v22 offset:8736
    s_waitcnt lgkmcnt(12)
    global_store_dwordx4 v19, v[76:79], s[46:47] offset:-1280 sc1
    ds_read_b64_tr_b16 v[104:105], v22 offset:8256
    ds_read_b64_tr_b16 v[106:107], v22 offset:8768
    s_waitcnt lgkmcnt(12)
    global_store_dwordx4 v19, v[80:83], s[46:47] offset:-1024 sc1
    ds_read_b64_tr_b16 v[108:109], v22 offset:8288
    ds_read_b64_tr_b16 v[110:111], v22 offset:8800
    s_waitcnt lgkmcnt(12)
    global_store_dwordx4 v19, v[84:87], s[46:47] offset:-768 sc1
    ds_read_b64_tr_b16 v[64:65], v22 offset:12288
    ds_read_b64_tr_b16 v[66:67], v22 offset:12800
    s_waitcnt lgkmcnt(12)
    global_store_dwordx4 v19, v[88:91], s[46:47] offset:-512 sc1
    ds_read_b64_tr_b16 v[68:69], v22 offset:12320
    ds_read_b64_tr_b16 v[70:71], v22 offset:12832
    s_waitcnt lgkmcnt(12)
    global_store_dwordx4 v19, v[92:95], s[46:47] offset:-256 sc1
    ds_read_b64_tr_b16 v[72:73], v22 offset:12352
    ds_read_b64_tr_b16 v[74:75], v22 offset:12864
    s_waitcnt lgkmcnt(12)
    global_store_dwordx4 v19, v[96:99], s[46:47] offset:0 sc1
    ds_read_b64_tr_b16 v[76:77], v22 offset:12384
    ds_read_b64_tr_b16 v[78:79], v22 offset:12896
    s_waitcnt lgkmcnt(12)
    global_store_dwordx4 v19, v[100:103], s[46:47] offset:256 sc1
    ds_read_b64_tr_b16 v[80:81], v22 offset:16384
    ds_read_b64_tr_b16 v[82:83], v22 offset:16896
    s_waitcnt lgkmcnt(12)
    global_store_dwordx4 v19, v[104:107], s[46:47] offset:512 sc1
    ds_read_b64_tr_b16 v[84:85], v22 offset:16416
    ds_read_b64_tr_b16 v[86:87], v22 offset:16928
    s_waitcnt lgkmcnt(12)
    global_store_dwordx4 v19, v[108:111], s[46:47] offset:768 sc1
    ds_read_b64_tr_b16 v[88:89], v22 offset:16448
    ds_read_b64_tr_b16 v[90:91], v22 offset:16960
    s_waitcnt lgkmcnt(12)
    global_store_dwordx4 v19, v[64:67], s[46:47] offset:1024 sc1
    ds_read_b64_tr_b16 v[92:93], v22 offset:16480
    ds_read_b64_tr_b16 v[94:95], v22 offset:16992
    s_waitcnt lgkmcnt(12)
    global_store_dwordx4 v19, v[68:71], s[46:47] offset:1280 sc1
    s_waitcnt lgkmcnt(10)
    global_store_dwordx4 v19, v[72:75], s[46:47] offset:1536 sc1
    s_waitcnt lgkmcnt(8)
    global_store_dwordx4 v19, v[76:79], s[46:47] offset:1792 sc1
    s_waitcnt lgkmcnt(6)
    global_store_dwordx4 v19, v[80:83], s[46:47] offset:2048 sc1
    s_waitcnt lgkmcnt(4)
    global_store_dwordx4 v19, v[84:87], s[46:47] offset:2304 sc1
    s_waitcnt lgkmcnt(2)
    global_store_dwordx4 v19, v[88:91], s[46:47] offset:2560 sc1
    s_waitcnt lgkmcnt(0)
    global_store_dwordx4 v19, v[92:95], s[46:47] offset:2816 sc1
    s_barrier
    v_mov_b32 v46, 0
    s_movk_i32 s11, 3072
    v_min_u32 v47, 9, v1
    v_mul_u32_u24 v47, s11, v47
    v_add_u32 v47, 119676, v47
    ds_write_b32 v47, v46
    global_load_dword v32, v30, s[44:45] sc1
    v_add_u32 v37, 368640, v37
    v_subrev_u32 v254, 2457600, v37
    v_min_u32_e64 v37, v37, v254
    global_load_dword v255, v37, s[36:37]
    global_load_dword v255, v38, s[16:17] offset:256
    s_mov_b32 s56, 1
Ls_kgen_39:
    s_nop 0
    v_pk_mul_f32 v[146:147], v[136:137], v[128:129] op_sel:[0,0] op_sel_hi:[0,1]
    v_pk_fma_f32 v[146:147], v[136:137], v[128:129], v[146:147] op_sel:[1,1,0] op_sel_hi:[1,0,1] neg_lo:[0,1,0]
    v_cvt_pk_bf16_f32 v176, v136, -v137
    v_pk_mul_f32 v[148:149], v[146:147], v[128:129] op_sel:[0,0] op_sel_hi:[0,1]
    v_pk_fma_f32 v[148:149], v[146:147], v[128:129], v[148:149] op_sel:[1,1,0] op_sel_hi:[1,0,1] neg_lo:[0,1,0]
    v_cvt_pk_bf16_f32 v177, v146, -v147
    s_mov_b32 m0, s5
    s_nop 0
    ds_write_addtid_b32 v176 offset:41280
    v_pk_mul_f32 v[150:151], v[148:149], v[128:129] op_sel:[0,0] op_sel_hi:[0,1]
    v_pk_fma_f32 v[150:151], v[148:149], v[128:129], v[150:151] op_sel:[1,1,0] op_sel_hi:[1,0,1] neg_lo:[0,1,0]
    v_cvt_pk_bf16_f32 v178, v148, -v149
    ds_write_addtid_b32 v177 offset:4128
    v_pk_mul_f32 v[152:153], v[150:151], v[128:129] op_sel:[0,0] op_sel_hi:[0,1]
    v_pk_fma_f32 v[152:153], v[150:151], v[128:129], v[152:153] op_sel:[1,1,0] op_sel_hi:[1,0,1] neg_lo:[0,1,0]
    v_cvt_pk_bf16_f32 v179, v150, -v151
    ds_write_addtid_b32 v178 offset:14448
    v_pk_mul_f32 v[154:155], v[152:153], v[128:129] op_sel:[0,0] op_sel_hi:[0,1]
    v_pk_fma_f32 v[154:155], v[152:153], v[128:129], v[154:155] op_sel:[1,1,0] op_sel_hi:[1,0,1] neg_lo:[0,1,0]
    v_cvt_pk_bf16_f32 v176, v152, -v153
    ds_write_addtid_b32 v179 offset:22704
    v_pk_mul_f32 v[156:157], v[154:155], v[128:129] op_sel:[0,0] op_sel_hi:[0,1]
    v_pk_fma_f32 v[156:157], v[154:155], v[128:129], v[156:157] op_sel:[1,1,0] op_sel_hi:[1,0,1] neg_lo:[0,1,0]
    v_cvt_pk_bf16_f32 v177, v154, -v155
    ds_write_addtid_b32 v176 offset:0
    v_pk_mul_f32 v[158:159], v[156:157], v[128:129] op_sel:[0,0] op_sel_hi:[0,1]
    v_pk_fma_f32 v[158:159], v[156:157], v[128:129], v[158:159] op_sel:[1,1,0] op_sel_hi:[1,0,1] neg_lo:[0,1,0]
    v_cvt_pk_bf16_f32 v178, v156, -v157
    ds_write_addtid_b32 v177 offset:18576
    v_pk_mul_f32 v[160:161], v[136:137], v[132:133] op_sel:[0,0] op_sel_hi:[0,1]
    v_pk_fma_f32 v[160:161], v[136:137], v[132:133], v[160:161] op_sel:[1,1,0] op_sel_hi:[1,0,1] neg_lo:[0,1,0]
    v_cvt_pk_bf16_f32 v179, v158, -v159
    ds_write_addtid_b32 v178 offset:2064
    v_pk_mul_f32 v[162:163], v[160:161], v[132:133] op_sel:[0,0] op_sel_hi:[0,1]
    v_pk_fma_f32 v[162:163], v[160:161], v[132:133], v[162:163] op_sel:[1,1,0] op_sel_hi:[1,0,1] neg_lo:[0,1,0]
    v_cvt_pk_bf16_f32 v176, v160, -v161
    ds_write_addtid_b32 v179 offset:16512
    v_pk_mul_f32 v[164:165], v[162:163], v[132:133] op_sel:[0,0] op_sel_hi:[0,1]
    v_pk_fma_f32 v[164:165], v[162:163], v[132:133], v[164:165] op_sel:[1,1,0] op_sel_hi:[1,0,1] neg_lo:[0,1,0]
    v_cvt_pk_bf16_f32 v177, v162, -v163
    ds_write_addtid_b32 v176 offset:26832
    v_pk_mul_f32 v[166:167], v[164:165], v[132:133] op_sel:[0,0] op_sel_hi:[0,1]
    v_pk_fma_f32 v[166:167], v[164:165], v[132:133], v[166:167] op_sel:[1,1,0] op_sel_hi:[1,0,1] neg_lo:[0,1,0]
    v_cvt_pk_bf16_f32 v178, v164, -v165
    ds_write_addtid_b32 v177 offset:8256
    v_pk_mul_f32 v[160:161], v[166:167], v[132:133] op_sel:[0,0] op_sel_hi:[0,1]
    v_pk_fma_f32 v[160:161], v[166:167], v[132:133], v[160:161] op_sel:[1,1,0] op_sel_hi:[1,0,1] neg_lo:[0,1,0]
    v_cvt_pk_bf16_f32 v179, v166, -v167
    ds_write_addtid_b32 v178 offset:43344
    v_pk_mul_f32 v[162:163], v[160:161], v[132:133] op_sel:[0,0] op_sel_hi:[0,1]
    v_pk_fma_f32 v[162:163], v[160:161], v[132:133], v[162:163] op_sel:[1,1,0] op_sel_hi:[1,0,1] neg_lo:[0,1,0]
    v_cvt_pk_bf16_f32 v176, v160, -v161
    ds_write_addtid_b32 v179 offset:6192
    v_pk_mul_f32 v[164:165], v[162:163], v[132:133] op_sel:[0,0] op_sel_hi:[0,1]
    v_pk_fma_f32 v[164:165], v[162:163], v[132:133], v[164:165] op_sel:[1,1,0] op_sel_hi:[1,0,1] neg_lo:[0,1,0]
    v_cvt_pk_bf16_f32 v177, v162, -v163
    ds_write_addtid_b32 v176 offset:37152
    v_pk_mul_f32 v[166:167], v[164:165], v[132:133] op_sel:[0,0] op_sel_hi:[0,1]
    v_pk_fma_f32 v[166:167], v[164:165], v[132:133], v[166:167] op_sel:[1,1,0] op_sel_hi:[1,0,1] neg_lo:[0,1,0]
    v_cvt_pk_bf16_f32 v178, v164, -v165
    ds_write_addtid_b32 v177 offset:35088
    v_pk_mul_f32 v[160:161], v[152:153], v[132:133] op_sel:[0,0] op_sel_hi:[0,1]
    v_pk_fma_f32 v[160:161], v[152:153], v[132:133], v[160:161] op_sel:[1,1,0] op_sel_hi:[1,0,1] neg_lo:[0,1,0]
    v_cvt_pk_bf16_f32 v179, v166, -v167
    ds_write_addtid_b32 v178 offset:10320
    v_pk_mul_f32 v[162:163], v[160:161], v[132:133] op_sel:[0,0] op_sel_hi:[0,1]
    v_pk_fma_f32 v[162:163], v[160:161], v[132:133], v[162:163] op_sel:[1,1,0] op_sel_hi:[1,0,1] neg_lo:[0,1,0]
    v_cvt_pk_bf16_f32 v176, v160, -v161
    ds_write_addtid_b32 v179 offset:33024
    v_pk_mul_f32 v[164:165], v[162:163], v[132:133] op_sel:[0,0] op_sel_hi:[0,1]
    v_pk_fma_f32 v[164:165], v[162:163], v[132:133], v[164:165] op_sel:[1,1,0] op_sel_hi:[1,0,1] neg_lo:[0,1,0]
    v_cvt_pk_bf16_f32 v177, v162, -v163
    ds_write_addtid_b32 v176 offset:12384
    v_pk_mul_f32 v[166:167], v[148:149], v[132:133] op_sel:[0,0] op_sel_hi:[0,1]
    v_pk_fma_f32 v[166:167], v[148:149], v[132:133], v[166:167] op_sel:[1,1,0] op_sel_hi:[1,0,1] neg_lo:[0,1,0]
    v_cvt_pk_bf16_f32 v178, v164, -v165
    ds_write_addtid_b32 v177 offset:30960
    v_pk_mul_f32 v[160:161], v[156:157], v[132:133] op_sel:[0,0] op_sel_hi:[0,1]
    v_pk_fma_f32 v[160:161], v[156:157], v[132:133], v[160:161] op_sel:[1,1,0] op_sel_hi:[1,0,1] neg_lo:[0,1,0]
    v_cvt_pk_bf16_f32 v179, v166, -v167
    ds_write_addtid_b32 v178 offset:20640
    s_cmp_eq_u32 s60, 7
    s_cbranch_scc1 Ls_o7_41
Ls_b7_42:
    v_cvt_pk_bf16_f32 v176, v160, -v161
    ds_write_addtid_b32 v179 offset:28896
    v_pk_mul_f32 v[162:163], v[130:131], v[130:131] op_sel:[0,0] op_sel_hi:[0,1]
    v_pk_fma_f32 v[162:163], v[130:131], v[130:131], v[162:163] op_sel:[1,1,0] op_sel_hi:[1,0,1] neg_lo:[0,1,0]
    v_cvt_pk_bf16_f32 v177, v130, v131
    ds_write_addtid_b32 v176 offset:45408
    v_pk_mul_f32 v[164:165], v[162:163], v[130:131] op_sel:[0,0] op_sel_hi:[0,1]
    v_pk_fma_f32 v[164:165], v[162:163], v[130:131], v[164:165] op_sel:[1,1,0] op_sel_hi:[1,0,1] neg_lo:[0,1,0]
    v_cvt_pk_bf16_f32 v178, v162, v163
    s_mov_b32 m0, s57
    s_nop 0
    ds_write_addtid_b32 v177 offset:2064
    v_pk_mul_f32 v[166:167], v[164:165], v[130:131] op_sel:[0,0] op_sel_hi:[0,1]
    v_pk_fma_f32 v[166:167], v[164:165], v[130:131], v[166:167] op_sel:[1,1,0] op_sel_hi:[1,0,1] neg_lo:[0,1,0]
    v_cvt_pk_bf16_f32 v179, v164, v165
    ds_write_addtid_b32 v178 offset:4128
    v_pk_mul_f32 v[160:161], v[166:167], v[130:131] op_sel:[0,0] op_sel_hi:[0,1]
    v_pk_fma_f32 v[160:161], v[166:167], v[130:131], v[160:161] op_sel:[1,1,0] op_sel_hi:[1,0,1] neg_lo:[0,1,0]
    v_cvt_pk_bf16_f32 v176, v166, v167
    ds_write_addtid_b32 v179 offset:6192
    ds_read_b128 v[64:67], v40 offset:0
    v_pk_mul_f32 v[162:163], v[160:161], v[130:131] op_sel:[0,0] op_sel_hi:[0,1]
    v_pk_fma_f32 v[162:163], v[160:161], v[130:131], v[162:163] op_sel:[1,1,0] op_sel_hi:[1,0,1] neg_lo:[0,1,0]
    v_cvt_pk_bf16_f32 v177, v160, v161
    ds_write_addtid_b32 v176 offset:8256
    v_pk_mul_f32 v[164:165], v[162:163], v[130:131] op_sel:[0,0] op_sel_hi:[0,1]
    v_pk_fma_f32 v[164:165], v[162:163], v[130:131], v[164:165] op_sel:[1,1,0] op_sel_hi:[1,0,1] neg_lo:[0,1,0]
    v_cvt_pk_bf16_f32 v178, v162, v163
    ds_write_addtid_b32 v177 offset:10320
    v_pk_mul_f32 v[166:167], v[164:165], v[130:131] op_sel:[0,0] op_sel_hi:[0,1]
    v_pk_fma_f32 v[166:167], v[164:165], v[130:131], v[166:167] op_sel:[1,1,0] op_sel_hi:[1,0,1] neg_lo:[0,1,0]
    v_cvt_pk_bf16_f32 v179, v164, v165
    ds_write_addtid_b32 v178 offset:12384
    ds_read_b128 v[72:75], v40 offset:32
    v_pk_mul_f32 v[160:161], v[166:167], v[130:131] op_sel:[0,0] op_sel_hi:[0,1]
    v_pk_fma_f32 v[160:161], v[166:167], v[130:131], v[160:161] op_sel:[1,1,0] op_sel_hi:[1,0,1] neg_lo:[0,1,0]
    v_cvt_pk_bf16_f32 v176, v166, v167
    ds_write_addtid_b32 v179 offset:14448
    v_pk_mul_f32 v[162:163], v[160:161], v[130:131] op_sel:[0,0] op_sel_hi:[0,1]
    v_pk_fma_f32 v[162:163], v[160:161], v[130:131], v[162:163] op_sel:[1,1,0] op_sel_hi:[1,0,1] neg_lo:[0,1,0]
    v_cvt_pk_bf16_f32 v177, v160, v161
    ds_write_addtid_b32 v176 offset:16512
    v_pk_mul_f32 v[164:165], v[162:163], v[130:131] op_sel:[0,0] op_sel_hi:[0,1]
    v_pk_fma_f32 v[164:165], v[162:163], v[130:131], v[164:165] op_sel:[1,1,0] op_sel_hi:[1,0,1] neg_lo:[0,1,0]
    v_cvt_pk_bf16_f32 v178, v162, v163
    ds_write_addtid_b32 v177 offset:18576
    ds_read_b128 v[80:83], v40 offset:64
    v_pk_mul_f32 v[166:167], v[164:165], v[130:131] op_sel:[0,0] op_sel_hi:[0,1]
    v_pk_fma_f32 v[166:167], v[164:165], v[130:131], v[166:167] op_sel:[1,1,0] op_sel_hi:[1,0,1] neg_lo:[0,1,0]
    v_cvt_pk_bf16_f32 v179, v164, v165
    ds_write_addtid_b32 v178 offset:20640
    v_pk_mul_f32 v[160:161], v[166:167], v[130:131] op_sel:[0,0] op_sel_hi:[0,1]
    v_pk_fma_f32 v[160:161], v[166:167], v[130:131], v[160:161] op_sel:[1,1,0] op_sel_hi:[1,0,1] neg_lo:[0,1,0]
    v_cvt_pk_bf16_f32 v176, v166, v167
    ds_write_addtid_b32 v179 offset:22704
    v_pk_mul_f32 v[162:163], v[160:161], v[130:131] op_sel:[0,0] op_sel_hi:[0,1]
    v_pk_fma_f32 v[162:163], v[160:161], v[130:131], v[162:163] op_sel:[1,1,0] op_sel_hi:[1,0,1] neg_lo:[0,1,0]
    v_cvt_pk_bf16_f32 v177, v160, v161
    ds_write_addtid_b32 v176 offset:24768
    ds_read_b128 v[88:91], v40 offset:96
    s_cmp_eq_u32 s60, 7
    s_cbranch_scc1 Ls_o7_43
Ls_b7_44:
    v_pk_mul_f32 v[164:165], v[162:163], v[130:131] op_sel:[0,0] op_sel_hi:[0,1]
    v_pk_fma_f32 v[164:165], v[162:163], v[130:131], v[164:165] op_sel:[1,1,0] op_sel_hi:[1,0,1] neg_lo:[0,1,0]
    v_cvt_pk_bf16_f32 v178, v162, v163
    ds_write_addtid_b32 v177 offset:26832
    v_pk_mul_f32 v[166:167], v[164:165], v[130:131] op_sel:[0,0] op_sel_hi:[0,1]
    v_pk_fma_f32 v[166:167], v[164:165], v[130:131], v[166:167] op_sel:[1,1,0] op_sel_hi:[1,0,1] neg_lo:[0,1,0]
    v_cvt_pk_bf16_f32 v179, v164, v165
    ds_write_addtid_b32 v178 offset:28896
    v_pk_mul_f32 v[160:161], v[166:167], v[130:131] op_sel:[0,0] op_sel_hi:[0,1]
    v_pk_fma_f32 v[160:161], v[166:167], v[130:131], v[160:161] op_sel:[1,1,0] op_sel_hi:[1,0,1] neg_lo:[0,1,0]
    v_cvt_pk_bf16_f32 v176, v166, v167
    ds_write_addtid_b32 v179 offset:30960
    ds_read_b128 v[96:99], v40 offset:128
    v_pk_mul_f32 v[162:163], v[160:161], v[130:131] op_sel:[0,0] op_sel_hi:[0,1]
    v_pk_fma_f32 v[162:163], v[160:161], v[130:131], v[162:163] op_sel:[1,1,0] op_sel_hi:[1,0,1] neg_lo:[0,1,0]
    v_cvt_pk_bf16_f32 v177, v160, v161
    ds_write_addtid_b32 v176 offset:33024
    v_pk_mul_f32 v[164:165], v[162:163], v[130:131] op_sel:[0,0] op_sel_hi:[0,1]
    v_pk_fma_f32 v[164:165], v[162:163], v[130:131], v[164:165] op_sel:[1,1,0] op_sel_hi:[1,0,1] neg_lo:[0,1,0]
    v_cvt_pk_bf16_f32 v178, v162, v163
    ds_write_addtid_b32 v177 offset:35088
    v_pk_mul_f32 v[166:167], v[164:165], v[130:131] op_sel:[0,0] op_sel_hi:[0,1]
    v_pk_fma_f32 v[166:167], v[164:165], v[130:131], v[166:167] op_sel:[1,1,0] op_sel_hi:[1,0,1] neg_lo:[0,1,0]
    v_cvt_pk_bf16_f32 v179, v164, v165
    ds_write_addtid_b32 v178 offset:37152
    ds_read_b128 v[104:107], v40 offset:160
    v_pk_mul_f32 v[160:161], v[166:167], v[130:131] op_sel:[0,0] op_sel_hi:[0,1]
    v_pk_fma_f32 v[160:161], v[166:167], v[130:131], v[160:161] op_sel:[1,1,0] op_sel_hi:[1,0,1] neg_lo:[0,1,0]
    v_cvt_pk_bf16_f32 v176, v166, v167
    ds_write_addtid_b32 v179 offset:39216
    v_pk_mul_f32 v[162:163], v[160:161], v[130:131] op_sel:[0,0] op_sel_hi:[0,1]
    v_pk_fma_f32 v[162:163], v[160:161], v[130:131], v[162:163] op_sel:[1,1,0] op_sel_hi:[1,0,1] neg_lo:[0,1,0]
    v_cvt_pk_bf16_f32 v177, v160, v161
    ds_write_addtid_b32 v176 offset:41280
    v_pk_mul_f32 v[164:165], v[162:163], v[130:131] op_sel:[0,0] op_sel_hi:[0,1]
    v_pk_fma_f32 v[164:165], v[162:163], v[130:131], v[164:165] op_sel:[1,1,0] op_sel_hi:[1,0,1] neg_lo:[0,1,0]
    v_cvt_pk_bf16_f32 v178, v162, v163
    ds_write_addtid_b32 v177 offset:43344
    ds_read_b128 v[112:115], v40 offset:192
    v_pk_mul_f32 v[166:167], v[164:165], v[130:131] op_sel:[0,0] op_sel_hi:[0,1]
    v_pk_fma_f32 v[166:167], v[164:165], v[130:131], v[166:167] op_sel:[1,1,0] op_sel_hi:[1,0,1] neg_lo:[0,1,0]
    v_cvt_pk_bf16_f32 v179, v164, v165
    ds_write_addtid_b32 v178 offset:45408
    v_pk_mul_f32 v[160:161], v[166:167], v[130:131] op_sel:[0,0] op_sel_hi:[0,1]
    v_pk_fma_f32 v[160:161], v[166:167], v[130:131], v[160:161] op_sel:[1,1,0] op_sel_hi:[1,0,1] neg_lo:[0,1,0]
    v_cvt_pk_bf16_f32 v176, v166, v167
    ds_write_addtid_b32 v179 offset:47472
    v_pk_mul_f32 v[162:163], v[160:161], v[130:131] op_sel:[0,0] op_sel_hi:[0,1]
    v_pk_fma_f32 v[162:163], v[160:161], v[130:131], v[162:163] op_sel:[1,1,0] op_sel_hi:[1,0,1] neg_lo:[0,1,0]
    v_cvt_pk_bf16_f32 v177, v160, v161
    ds_write_addtid_b32 v176 offset:49536
    ds_read_b128 v[120:123], v40 offset:224
    v_pk_mul_f32 v[164:165], v[162:163], v[130:131] op_sel:[0,0] op_sel_hi:[0,1]
    v_pk_fma_f32 v[164:165], v[162:163], v[130:131], v[164:165] op_sel:[1,1,0] op_sel_hi:[1,0,1] neg_lo:[0,1,0]
    v_cvt_pk_bf16_f32 v178, v162, v163
    ds_write_addtid_b32 v177 offset:51600
    v_pk_mul_f32 v[166:167], v[164:165], v[130:131] op_sel:[0,0] op_sel_hi:[0,1]
    v_pk_fma_f32 v[166:167], v[164:165], v[130:131], v[166:167] op_sel:[1,1,0] op_sel_hi:[1,0,1] neg_lo:[0,1,0]
    v_cvt_pk_bf16_f32 v179, v164, v165
    ds_write_addtid_b32 v178 offset:53664
    v_pk_mul_f32 v[160:161], v[166:167], v[130:131] op_sel:[0,0] op_sel_hi:[0,1]
    v_pk_fma_f32 v[160:161], v[166:167], v[130:131], v[160:161] op_sel:[1,1,0] op_sel_hi:[1,0,1] neg_lo:[0,1,0]
    v_cvt_pk_bf16_f32 v176, v166, v167
    ds_write_addtid_b32 v179 offset:55728
    v_pk_mul_f32 v[162:163], v[160:161], v[130:131] op_sel:[0,0] op_sel_hi:[0,1]
    v_pk_fma_f32 v[162:163], v[160:161], v[130:131], v[162:163] op_sel:[1,1,0] op_sel_hi:[1,0,1] neg_lo:[0,1,0]
    v_cvt_pk_bf16_f32 v177, v160, v161
    ds_write_addtid_b32 v176 offset:57792
    v_pk_mul_f32 v[164:165], v[162:163], v[130:131] op_sel:[0,0] op_sel_hi:[0,1]
    v_pk_fma_f32 v[164:165], v[162:163], v[130:131], v[164:165] op_sel:[1,1,0] op_sel_hi:[1,0,1] neg_lo:[0,1,0]
    v_cvt_pk_bf16_f32 v178, v162, v163
    ds_write_addtid_b32 v177 offset:59856
    v_cvt_pk_bf16_f32 v179, v164, v165
    ds_write_addtid_b32 v178 offset:61920
    ds_write_addtid_b32 v179 offset:63984
    s_cmp_eq_u32 s60, 7
    s_cbranch_scc1 Ls_o7_47
Ls_b7_48:
    s_barrier
    ds_read_b128 v[68:71], v40 offset:49536
    ds_read_b128 v[76:79], v40 offset:49568
    ds_read_b128 v[84:87], v40 offset:49600
    ds_read_b128 v[92:95], v40 offset:49632
    ds_read_b128 v[100:103], v40 offset:49664
    ds_read_b128 v[108:111], v40 offset:49696
    ds_read_b128 v[116:119], v40 offset:49728
    ds_read_b128 v[124:127], v40 offset:49760
    s_cmp_lg_u32 s56, 0
    s_cbranch_scc1 Ls_r0_49
    s_waitcnt vmcnt(0)
    s_xor_b32 exec_hi, s10, 1
    s_mov_b32 exec_lo, 0
    v_mov_b32 v56, v17
    s_mov_b64 exec, -1
    v_lshlrev_b32_e64 v46, 2, v0
    v_add_u32 v46, L_tab_src-Ls_pc_36, v46
    global_load_dwordx2 v[34:35], v46, s[64:65]
    s_cmp_lt_u32 s60, 5
    s_cbranch_scc1 Ls_r0_49
    v_lshlrev_b32_e64 v46, 4, v1
    v_add_u32 v46, L_tab_band-Ls_pc_36+2048, v46
    global_load_dwordx4 v[200:203], v46, s[64:65] offset:-2048
    global_load_dwordx4 v[204:207], v46, s[64:65] offset:-1024
    global_load_dwordx4 v[208:211], v46, s[64:65] offset:0
    global_load_dwordx4 v[212:215], v46, s[64:65] offset:1024
    global_load_dwordx4 v[216:219], v46, s[64:65] offset:2048
    global_load_dwordx4 v[220:223], v46, s[64:65] offset:3072
Ls_r0_49:
    s_mul_i32 s9, s6, 6144
    s_mul_i32 s11, s10, 3072
    s_add_u32 s9, s9, s11
    s_add_u32 s9, s9, 116608
    v_lshl_add_u32 v41, v9, 2, s9
    v_mul_f32 v134, 0x3fb8aa3b, v16
    v_exp_f32 v134, v134
    v_mul_f32 v140, v12, v10
    v_mul_f32 v141, v12, v11
    v_cvt_pk_bf16_f32 v134, v134, v134
    v_fma_f32 v140, -v13, v11, v140
    v_and_b32 v134, 0xffff0000, v134
    v_fmac_f32 v141, v13, v10
    s_waitcnt lgkmcnt(7)
    v_mfma_f32_32x32x16_bf16 v[48:63], v[64:67], v[68:71], v[48:63]
    v_mul_f32 v14, v134, v14
    v_mul_f32 v15, v134, v15
    v_mul_f32 v136, v134, v140
    v_mul_f32_e64 v137, v134, v141
    s_waitcnt lgkmcnt(6)
    v_mfma_f32_32x32x16_bf16 v[48:63], v[72:75], v[76:79], v[48:63]
    v_mul_f32 v14, 0x3fb8aa3b, v14
    v_mul_f32 v15, 0.15915494, v15
    v_exp_f32 v140, v14
    v_rndne_f32 v142, v15
    s_waitcnt lgkmcnt(5)
    v_mfma_f32_32x32x16_bf16 v[48:63], v[80:83], v[84:87], v[48:63]
    v_sub_f32 v15, v15, v142
    v_cos_f32 v128, v15
    v_sin_f32 v129, v15
    v_mul_f32 v14, 0x43800000, v14
    s_waitcnt lgkmcnt(4)
    v_mfma_f32_32x32x16_bf16 v[48:63], v[88:91], v[92:95], v[48:63]
    v_mul_f32 v15, 0x43800000, v15
    v_mul_f32 v128, v128, v140
    v_mul_f32 v129, v129, v140
    v_exp_f32 v142, v14
    s_waitcnt lgkmcnt(3)
    v_mfma_f32_32x32x16_bf16 v[48:63], v[96:99], v[100:103], v[48:63]
    v_cos_f32 v132, v15
    v_sin_f32 v133, v15
    v_mul_f32 v130, v128, v128
    v_mul_f32_e64 v131, v128, v129
    s_waitcnt lgkmcnt(2)
    v_mfma_f32_32x32x16_bf16 v[48:63], v[104:107], v[108:111], v[48:63]
    v_fma_f32 v130, -v129, v129, v130
    v_add_f32 v131, v131, v131
    v_mul_f32 v132, v132, v142
    v_mul_f32 v133, v133, v142
    s_waitcnt lgkmcnt(1)
    v_mfma_f32_32x32x16_bf16 v[48:63], v[112:115], v[116:119], v[48:63]
    v_mul_f32 v140, v130, v130
    v_mul_f32 v141, v130, v131
    v_fma_f32 v140, -v131, v131, v140
    v_add_f32 v141, v141, v141
    s_waitcnt lgkmcnt(0)
    v_mfma_f32_32x32x16_bf16 v[48:63], v[120:123], v[124:127], v[48:63]
    v_mul_f32 v130, v140, v140
    v_mul_f32 v131, v140, v141
    v_fma_f32 v130, -v141, v141, v130
    v_add_f32 v131, v131, v131
    s_or_b32 s9, s10, s56
    s_cbranch_scc0 Ls_noflush_50
    s_nop 5
    ds_write_b32 v41, v48 offset:0
    ds_write_b32 v41, v49 offset:276
    ds_write_b32 v41, v50 offset:552
    ds_write_b32 v41, v51 offset:828
    ds_write_b32 v41, v52 offset:1104
    ds_write_b32 v41, v53 offset:1380
    ds_write_b32 v41, v54 offset:1656
    ds_write_b32 v41, v55 offset:1932
    ds_write_b32 v41, v56 offset:2208
    ds_write_b32 v41, v57 offset:2484
    ds_write_b32 v41, v58 offset:2760
    v_mov_b32 v48, 0
    v_mov_b32 v49, 0
    v_mov_b32 v50, 0
    v_mov_b32 v51, 0
    v_mov_b32 v52, 0
    v_mov_b32 v53, 0
    v_mov_b32 v54, 0
    v_mov_b32 v55, 0
    v_mov_b32 v56, 0
    v_mov_b32 v57, 0
    v_mov_b32 v58, 0
Ls_noflush_50:
    s_mov_b32 s6, s7
    s_xor_b32 s56, s56, 1
    s_cbranch_scc1 Ls_kgen_39
    s_cmp_lg_u32 s60, 7
    s_cbranch_scc1 Ls_w7_52
    s_waitcnt vmcnt(3)
    v_readfirstlane_b32 s9, v21
    s_nop 0
    s_cmp_eq_u32 s9, 64
    s_cbranch_scc1 Ls_uk_53
    s_mov_b32 s13, 32768
    v_mov_b32 v22, 0
    s_mov_b64 exec, 1
Lpoll_54:
    global_atomic_add v21, v20, v22, s[46:47] sc0 sc1
    s_sub_u32 s13, s13, 1
    s_cselect_b32 s12, 0, -1
    s_waitcnt vmcnt(0)
    v_cmp_ne_u32 vcc, 64, v21
    s_nop 0
    s_and_b32 s12, s12, vcc_lo
    s_cbranch_scc1 Lpoll_54
    s_mov_b64 exec, -1
Ls_uk_53:
    s_setprio 0
    s_branch Ls_u7_51
Ls_w7_52:
    s_waitcnt vmcnt(0)
Ls_u7_51:
    v_and_b32 v36, 0xffff, v35
    v_lshrrev_b32_e64 v35, 16, v34
    v_and_b32 v34, 0xffff, v34
    v_add_u32 v34, 116608, v34
    v_add_u32 v35, 116608, v35
    v_add_u32 v36, 116608, v36
    v_mul_u32_u24 v13, 2185, v0
    v_lshrrev_b32_e64 v13, 16, v13
    v_mul_u32_u24 v13, 4160, v13
    v_lshl_add_u32 v13, v0, 4, v13
    v_mov_b32 v20, 0
    v_mov_b32 v21, 0
    v_mov_b32 v22, 0
    v_mov_b32 v23, 0
    v_and_b32 v14, 15, v1
    v_lshrrev_b32 v15, 4, v1
    v_and_b32 v16, 3, v14
    v_sub_u32 v16, 3, v16
    v_mul_u32_u24 v16, 2112, v16
    v_lshrrev_b32 v17, 2, v14
    v_sub_u32 v17, 3, v17
    v_lshl_add_u32 v16, v17, 3, v16
    v_add_u32 v16, 51200, v16
    v_add_u32 v13, 93440, v13
    v_lshlrev_b32 v17, 5, v14
    v_and_b32 v18, 1, v15
    v_lshl_add_u32 v18, v18, 9, v17
    v_and_b32_e64 v19, 2, v15
    v_lshl_add_u32 v18, v19, 3, v18
    v_lshl_add_u32 v17, v15, 4, v17
    v_add_u32 v17, 93440, v17
    s_waitcnt lgkmcnt(0)
    s_barrier
    global_load_dwordx4 v[128:131], v24, s[46:47] sc1
    global_load_dwordx4 v[132:135], v25, s[46:47] sc1
    global_load_dwordx4 v[136:139], v26, s[46:47] sc1
    ds_read2st64_b32 v[64:65], v34 offset0:0 offset1:12
    ds_read2st64_b32 v[66:67], v35 offset0:0 offset1:12
    ds_read2st64_b32 v[68:69], v36 offset0:0 offset1:12
    ds_read2st64_b32 v[70:71], v34 offset0:24 offset1:36
    ds_read2st64_b32 v[72:73], v35 offset0:24 offset1:36
    ds_read2st64_b32 v[74:75], v36 offset0:24 offset1:36
    ds_read2st64_b32 v[76:77], v34 offset0:48 offset1:60
    ds_read2st64_b32 v[78:79], v35 offset0:48 offset1:60
    ds_read2st64_b32 v[80:81], v36 offset0:48 offset1:60
    ds_read2st64_b32 v[82:83], v34 offset0:72 offset1:84
    ds_read2st64_b32 v[84:85], v35 offset0:72 offset1:84
    ds_read2st64_b32 v[86:87], v36 offset0:72 offset1:84
    ds_read2st64_b32 v[88:89], v34 offset0:96 offset1:108
    ds_read2st64_b32 v[90:91], v35 offset0:96 offset1:108
    ds_read2st64_b32 v[92:93], v36 offset0:96 offset1:108
    v_cmp_gt_u32 vcc, 150, v0
    s_nop 0
    s_and_saveexec_b64 s[12:13], vcc
    ds_write_b128 v13, v[20:23]
    s_mov_b64 exec, s[12:13]
    s_add_u32 m0, s5, 51200
    s_waitcnt lgkmcnt(1)
    v_add_f32 v64, v64, v65
    v_add_f32 v66, v66, v67
    v_add_f32_e64 v68, v68, v69
    v_cvt_pk_bf16_f32 v65, v64, v66
    v_cvt_pk_bf16_f32 v67, v66, v68
    ds_write_addtid_b32 v65 offset:0
    ds_write_addtid_b32 v67 offset:2112
    ds_write_addtid_b32 v65 offset:4220
    ds_write_addtid_b32 v67 offset:6332
    v_add_f32 v70, v70, v71
    v_add_f32 v72, v72, v73
    v_add_f32_e64 v74, v74, v75
    v_cvt_pk_bf16_f32 v71, v70, v72
    v_cvt_pk_bf16_f32 v73, v72, v74
    ds_write_addtid_b32 v71 offset:8448
    ds_write_addtid_b32 v73 offset:10560
    ds_write_addtid_b32 v71 offset:12668
    ds_write_addtid_b32 v73 offset:14780
    v_add_f32 v76, v76, v77
    v_add_f32 v78, v78, v79
    v_add_f32_e64 v80, v80, v81
    v_cvt_pk_bf16_f32 v77, v76, v78
    v_cvt_pk_bf16_f32 v79, v78, v80
    ds_write_addtid_b32 v77 offset:16896
    ds_write_addtid_b32 v79 offset:19008
    ds_write_addtid_b32 v77 offset:21116
    ds_write_addtid_b32 v79 offset:23228
    v_add_f32 v82, v82, v83
    v_add_f32 v84, v84, v85
    v_add_f32_e64 v86, v86, v87
    v_cvt_pk_bf16_f32 v83, v82, v84
    v_cvt_pk_bf16_f32 v85, v84, v86
    ds_write_addtid_b32 v83 offset:25344
    ds_write_addtid_b32 v85 offset:27456
    ds_write_addtid_b32 v83 offset:29564
    ds_write_addtid_b32 v85 offset:31676
    v_add_f32 v88, v88, v89
    v_add_f32 v90, v90, v91
    v_add_f32_e64 v92, v92, v93
    v_cvt_pk_bf16_f32 v89, v88, v90
    v_cvt_pk_bf16_f32 v91, v90, v92
    ds_write_addtid_b32 v89 offset:33792
    ds_write_addtid_b32 v91 offset:35904
    ds_write_addtid_b32 v89 offset:38012
    ds_write_addtid_b32 v91 offset:40124
    s_waitcnt vmcnt(2)
    ds_write_b128 v27, v[128:131]
    s_waitcnt vmcnt(1)
    ds_write_b128 v28, v[132:135]
    s_waitcnt vmcnt(0)
    ds_write_b128 v29, v[136:139]
    s_cmp_lg_u32 s60, 7
    s_cbranch_scc1 Ls_w7_55
    s_nop 0
    v_min_u32 v39, 819196, v39
    global_load_dword v255, v39, s[38:39]
    v_add_u32 v39, 15360, v39
    v_min_u32 v39, 819196, v39
    global_load_dword v255, v39, s[38:39]
    v_add_u32 v39, 15360, v39
Ls_w7_55:
    s_cmp_ge_u32 s60, 5
    s_cbranch_scc1 Ls_dil_56
    s_mul_i32 s9, s60, 8448
    v_lshl_add_u32 v2, v15, 4, v16
    v_add_u32 v2, s9, v2
    s_mul_i32 s9, s60, 4640
    v_add_u32 v3, s9, v17
    s_mul_i32 s9, s60, 10240
    s_add_u32 s9, s9, 0
    v_lshl_add_u32 v4, v1, 4, s9
    s_add_u32 s52, s46, 4194304
    s_addc_u32 s53, s47, 0
    s_mov_b32 s54, 2621440
    s_mov_b32 s55, 0x20000
    s_mul_i32 s9, s61, 5
    s_add_u32 s9, s9, s60
    s_lshl_b32 s56, s9, 12
    s_waitcnt lgkmcnt(0)
    s_barrier
    ds_read_b64 v[84:85], v2 offset:576
    ds_read_b64 v[86:87], v2 offset:584
    ds_read_b64 v[116:117], v2 offset:64
    ds_read_b64 v[118:119], v2 offset:72
    ds_read_b128 v[128:131], v3 offset:0
    ds_read_b64 v[80:81], v2 offset:640
    ds_read_b64 v[82:83], v2 offset:648
    ds_read_b64 v[112:113], v2 offset:128
    ds_read_b64 v[114:115], v2 offset:136
    ds_read_b128 v[132:135], v3 offset:64
    ds_read_b64 v[76:77], v2 offset:704
    ds_read_b64 v[78:79], v2 offset:712
    ds_read_b64 v[108:109], v2 offset:192
    ds_read_b64 v[110:111], v2 offset:200
    ds_read_b128 v[136:139], v3 offset:128
    s_waitcnt lgkmcnt(10)
    v_mfma_f32_16x16x32_bf16 v[24:27], v[84:87], v[128:131], 0
    ds_read_b64 v[72:73], v2 offset:768
    ds_read_b64 v[74:75], v2 offset:776
    ds_read_b64 v[104:105], v2 offset:256
    v_mfma_f32_16x16x32_bf16 v[28:31], v[116:119], v[128:131], 0
    ds_read_b64 v[106:107], v2 offset:264
    ds_read_b128 v[140:143], v3 offset:192
    ds_read_b64 v[68:69], v2 offset:832
    s_waitcnt lgkmcnt(11)
    v_mfma_f32_16x16x32_bf16 v[24:27], v[80:83], v[132:135], v[24:27]
    ds_read_b64 v[70:71], v2 offset:840
    ds_read_b64 v[100:101], v2 offset:320
    ds_read_b64 v[102:103], v2 offset:328
    v_mfma_f32_16x16x32_bf16 v[28:31], v[112:115], v[132:135], v[28:31]
    ds_read_b128 v[144:147], v3 offset:256
    ds_read_b64 v[64:65], v2 offset:896
    ds_read_b64 v[66:67], v2 offset:904
    s_waitcnt lgkmcnt(12)
    v_mfma_f32_16x16x32_bf16 v[24:27], v[76:79], v[136:139], v[24:27]
    ds_read_b64 v[96:97], v2 offset:384
    ds_read_b64 v[98:99], v2 offset:392
    ds_read_b128 v[148:151], v3 offset:320
    v_mfma_f32_16x16x32_bf16 v[28:31], v[108:111], v[136:139], v[28:31]
    ds_read_b64 v[60:61], v2 offset:960
    ds_read_b64 v[62:63], v2 offset:968
    ds_read_b64 v[92:93], v2 offset:448
    s_waitcnt lgkmcnt(13)
    v_mfma_f32_16x16x32_bf16 v[24:27], v[72:75], v[140:143], v[24:27]
    ds_read_b64 v[94:95], v2 offset:456
    ds_read_b128 v[152:155], v3 offset:384
    ds_read_b64 v[56:57], v2 offset:1024
    v_mfma_f32_16x16x32_bf16 v[28:31], v[104:107], v[140:143], v[28:31]
    ds_read_b64 v[58:59], v2 offset:1032
    ds_read_b64 v[88:89], v2 offset:512
    ds_read_b64 v[90:91], v2 offset:520
    s_waitcnt lgkmcnt(14)
    v_mfma_f32_16x16x32_bf16 v[24:27], v[68:71], v[144:147], v[24:27]
    ds_read_b64 v[120:121], v2 offset:0
    ds_read_b64 v[122:123], v2 offset:8
    ds_read_b64 v[124:125], v2 offset:1120
    v_mfma_f32_16x16x32_bf16 v[28:31], v[100:103], v[144:147], v[28:31]
    ds_read_b64 v[126:127], v2 offset:1128
    ds_read_b128 v[156:159], v3 offset:448
    ds_read_b128 v[160:163], v3 offset:512
    s_waitcnt lgkmcnt(15)
    v_mfma_f32_16x16x32_bf16 v[24:27], v[64:67], v[148:151], v[24:27]
    ds_read_b128 v[164:167], v3 offset:576
    ds_read_b128 v[168:171], v3 offset:640
    ds_read_b128 v[172:175], v3 offset:704
    v_mfma_f32_16x16x32_bf16 v[28:31], v[96:99], v[148:151], v[28:31]
    ds_read_b128 v[128:131], v3 offset:768
    ds_read_b128 v[132:135], v3 offset:832
    ds_read_b128 v[136:139], v3 offset:896
    s_waitcnt lgkmcnt(15)
    v_mfma_f32_16x16x32_bf16 v[24:27], v[60:63], v[152:155], v[24:27]
    ds_read_b128 v[140:143], v3 offset:960
    ds_read_b128 v[144:147], v3 offset:1024
    v_mfma_f32_16x16x32_bf16 v[28:31], v[92:95], v[152:155], v[28:31]
    s_waitcnt lgkmcnt(9)
    v_mfma_f32_16x16x32_bf16 v[24:27], v[56:59], v[156:159], v[24:27]
    ds_read_b128 v[148:151], v3 offset:1088
    v_mfma_f32_16x16x32_bf16 v[28:31], v[88:91], v[156:159], v[28:31]
    v_mfma_f32_16x16x32_bf16 v[32:35], v[120:123], v[156:159], 0
    v_mfma_f32_16x16x32_bf16 v[40:43], v[124:127], v[156:159], 0
    s_waitcnt lgkmcnt(9)
    v_mfma_f32_16x16x32_bf16 v[28:31], v[84:87], v[160:163], v[28:31]
    ds_read_b128 v[152:155], v3 offset:1152
    v_mfma_f32_16x16x32_bf16 v[32:35], v[116:119], v[160:163], v[32:35]
    s_waitcnt lgkmcnt(9)
    v_mfma_f32_16x16x32_bf16 v[28:31], v[80:83], v[164:167], v[28:31]
    ds_read_b128 v[156:159], v3 offset:1216
    v_mfma_f32_16x16x32_bf16 v[32:35], v[112:115], v[164:167], v[32:35]
    s_waitcnt lgkmcnt(9)
    v_mfma_f32_16x16x32_bf16 v[28:31], v[76:79], v[168:171], v[28:31]
    ds_read_b128 v[160:163], v3 offset:1280
    v_mfma_f32_16x16x32_bf16 v[32:35], v[108:111], v[168:171], v[32:35]
    s_waitcnt lgkmcnt(9)
    v_mfma_f32_16x16x32_bf16 v[28:31], v[72:75], v[172:175], v[28:31]
    ds_read_b128 v[164:167], v3 offset:1344
    v_mfma_f32_16x16x32_bf16 v[32:35], v[104:107], v[172:175], v[32:35]
    s_waitcnt lgkmcnt(9)
    v_mfma_f32_16x16x32_bf16 v[28:31], v[68:71], v[128:131], v[28:31]
    ds_read_b128 v[168:171], v3 offset:1408
    v_mfma_f32_16x16x32_bf16 v[32:35], v[100:103], v[128:131], v[32:35]
    s_waitcnt lgkmcnt(9)
    v_mfma_f32_16x16x32_bf16 v[28:31], v[64:67], v[132:135], v[28:31]
    ds_read_b128 v[172:175], v3 offset:1472
    v_mfma_f32_16x16x32_bf16 v[32:35], v[96:99], v[132:135], v[32:35]
    s_waitcnt lgkmcnt(9)
    v_mfma_f32_16x16x32_bf16 v[28:31], v[60:63], v[136:139], v[28:31]
    ds_read_b128 v[128:131], v3 offset:1536
    v_mfma_f32_16x16x32_bf16 v[32:35], v[92:95], v[136:139], v[32:35]
    s_waitcnt lgkmcnt(9)
    v_mfma_f32_16x16x32_bf16 v[28:31], v[56:59], v[140:143], v[28:31]
    ds_read_b128 v[132:135], v3 offset:1600
    v_mfma_f32_16x16x32_bf16 v[32:35], v[88:91], v[140:143], v[32:35]
    v_mfma_f32_16x16x32_bf16 v[36:39], v[120:123], v[140:143], 0
    v_mfma_f32_16x16x32_bf16 v[44:47], v[124:127], v[140:143], 0
    s_waitcnt lgkmcnt(9)
    v_mfma_f32_16x16x32_bf16 v[32:35], v[84:87], v[144:147], v[32:35]
    ds_read_b128 v[136:139], v3 offset:1664
    v_mfma_f32_16x16x32_bf16 v[36:39], v[116:119], v[144:147], v[36:39]
    s_waitcnt lgkmcnt(9)
    v_mfma_f32_16x16x32_bf16 v[32:35], v[80:83], v[148:151], v[32:35]
    ds_read_b128 v[140:143], v3 offset:1728
    v_mfma_f32_16x16x32_bf16 v[36:39], v[112:115], v[148:151], v[36:39]
    s_waitcnt lgkmcnt(9)
    v_mfma_f32_16x16x32_bf16 v[32:35], v[76:79], v[152:155], v[32:35]
    ds_read_b128 v[144:147], v3 offset:1792
    v_mfma_f32_16x16x32_bf16 v[36:39], v[108:111], v[152:155], v[36:39]
    s_waitcnt lgkmcnt(9)
    v_mfma_f32_16x16x32_bf16 v[32:35], v[72:75], v[156:159], v[32:35]
    ds_read_b128 v[148:151], v3 offset:1856
    v_mfma_f32_16x16x32_bf16 v[36:39], v[104:107], v[156:159], v[36:39]
    s_waitcnt lgkmcnt(9)
    v_mfma_f32_16x16x32_bf16 v[32:35], v[68:71], v[160:163], v[32:35]
    ds_read_b128 v[152:155], v3 offset:1920
    v_mfma_f32_16x16x32_bf16 v[36:39], v[100:103], v[160:163], v[36:39]
    s_waitcnt lgkmcnt(9)
    v_mfma_f32_16x16x32_bf16 v[32:35], v[64:67], v[164:167], v[32:35]
    ds_read_b128 v[156:159], v3 offset:1984
    v_mfma_f32_16x16x32_bf16 v[36:39], v[96:99], v[164:167], v[36:39]
    s_waitcnt lgkmcnt(9)
    v_mfma_f32_16x16x32_bf16 v[32:35], v[60:63], v[168:171], v[32:35]
    ds_read_b128 v[160:163], v3 offset:2048
    v_mfma_f32_16x16x32_bf16 v[36:39], v[92:95], v[168:171], v[36:39]
    s_waitcnt lgkmcnt(9)
    v_mfma_f32_16x16x32_bf16 v[32:35], v[56:59], v[172:175], v[32:35]
    ds_read_b128 v[164:167], v3 offset:2112
    v_mfma_f32_16x16x32_bf16 v[36:39], v[88:91], v[172:175], v[36:39]
    v_mfma_f32_16x16x32_bf16 v[40:43], v[120:123], v[172:175], v[40:43]
    v_mfma_f32_16x16x32_bf16 v[48:51], v[124:127], v[172:175], 0
    s_waitcnt lgkmcnt(9)
    v_mfma_f32_16x16x32_bf16 v[36:39], v[84:87], v[128:131], v[36:39]
    ds_read_b128 v[168:171], v3 offset:2176
    v_cvt_pk_bf16_f32 v24, v24, v25
    v_cvt_pk_bf16_f32 v25, v26, v27
    v_mfma_f32_16x16x32_bf16 v[40:43], v[116:119], v[128:131], v[40:43]
    v_cvt_pk_bf16_f32 v26, v28, v29
    v_cvt_pk_bf16_f32 v27, v30, v31
    s_waitcnt lgkmcnt(9)
    v_mfma_f32_16x16x32_bf16 v[36:39], v[80:83], v[132:135], v[36:39]
    ds_read_b128 v[172:175], v3 offset:2240
    v_permlane16_swap_b32 v24, v26
    v_permlane16_swap_b32 v25, v27
    v_mfma_f32_16x16x32_bf16 v[40:43], v[112:115], v[132:135], v[40:43]
    s_waitcnt lgkmcnt(9)
    v_mfma_f32_16x16x32_bf16 v[36:39], v[76:79], v[136:139], v[36:39]
    ds_read_b128 v[128:131], v3 offset:2304
    v_mfma_f32_16x16x32_bf16 v[40:43], v[108:111], v[136:139], v[40:43]
    s_waitcnt lgkmcnt(9)
    v_mfma_f32_16x16x32_bf16 v[36:39], v[72:75], v[140:143], v[36:39]
    ds_read_b128 v[132:135], v3 offset:2368
    v_mfma_f32_16x16x32_bf16 v[40:43], v[104:107], v[140:143], v[40:43]
    s_waitcnt lgkmcnt(9)
    v_mfma_f32_16x16x32_bf16 v[36:39], v[68:71], v[144:147], v[36:39]
    ds_read_b128 v[136:139], v3 offset:2432
    v_mfma_f32_16x16x32_bf16 v[40:43], v[100:103], v[144:147], v[40:43]
    s_waitcnt lgkmcnt(9)
    v_mfma_f32_16x16x32_bf16 v[36:39], v[64:67], v[148:151], v[36:39]
    ds_read_b128 v[140:143], v3 offset:2496
    v_mfma_f32_16x16x32_bf16 v[40:43], v[96:99], v[148:151], v[40:43]
    s_waitcnt lgkmcnt(9)
    v_mfma_f32_16x16x32_bf16 v[36:39], v[60:63], v[152:155], v[36:39]
    ds_read_b128 v[144:147], v3 offset:2560
    v_mfma_f32_16x16x32_bf16 v[40:43], v[92:95], v[152:155], v[40:43]
    s_waitcnt lgkmcnt(9)
    v_mfma_f32_16x16x32_bf16 v[36:39], v[56:59], v[156:159], v[36:39]
    ds_read_b128 v[148:151], v3 offset:2624
    v_mfma_f32_16x16x32_bf16 v[40:43], v[88:91], v[156:159], v[40:43]
    v_mfma_f32_16x16x32_bf16 v[44:47], v[120:123], v[156:159], v[44:47]
    v_mfma_f32_16x16x32_bf16 v[52:55], v[124:127], v[156:159], 0
    s_waitcnt lgkmcnt(9)
    v_mfma_f32_16x16x32_bf16 v[40:43], v[84:87], v[160:163], v[40:43]
    ds_read_b128 v[152:155], v3 offset:2688
    v_mfma_f32_16x16x32_bf16 v[44:47], v[116:119], v[160:163], v[44:47]
    s_waitcnt lgkmcnt(9)
    v_mfma_f32_16x16x32_bf16 v[40:43], v[80:83], v[164:167], v[40:43]
    ds_read_b128 v[156:159], v3 offset:2752
    v_mfma_f32_16x16x32_bf16 v[44:47], v[112:115], v[164:167], v[44:47]
    s_waitcnt lgkmcnt(9)
    v_mfma_f32_16x16x32_bf16 v[40:43], v[76:79], v[168:171], v[40:43]
    ds_read_b128 v[160:163], v3 offset:2816
    v_mfma_f32_16x16x32_bf16 v[44:47], v[108:111], v[168:171], v[44:47]
    s_waitcnt lgkmcnt(9)
    v_mfma_f32_16x16x32_bf16 v[40:43], v[72:75], v[172:175], v[40:43]
    ds_read_b128 v[164:167], v3 offset:2880
    v_mfma_f32_16x16x32_bf16 v[44:47], v[104:107], v[172:175], v[44:47]
    s_waitcnt lgkmcnt(9)
    v_mfma_f32_16x16x32_bf16 v[40:43], v[68:71], v[128:131], v[40:43]
    ds_read_b128 v[168:171], v3 offset:2944
    v_mfma_f32_16x16x32_bf16 v[44:47], v[100:103], v[128:131], v[44:47]
    s_waitcnt lgkmcnt(9)
    v_mfma_f32_16x16x32_bf16 v[40:43], v[64:67], v[132:135], v[40:43]
    ds_read_b128 v[172:175], v3 offset:3008
    v_mfma_f32_16x16x32_bf16 v[44:47], v[96:99], v[132:135], v[44:47]
    s_waitcnt lgkmcnt(9)
    v_mfma_f32_16x16x32_bf16 v[40:43], v[60:63], v[136:139], v[40:43]
    ds_read_b128 v[128:131], v3 offset:3072
    v_mfma_f32_16x16x32_bf16 v[44:47], v[92:95], v[136:139], v[44:47]
    s_waitcnt lgkmcnt(9)
    v_mfma_f32_16x16x32_bf16 v[40:43], v[56:59], v[140:143], v[40:43]
    ds_read_b128 v[132:135], v3 offset:3136
    v_mfma_f32_16x16x32_bf16 v[44:47], v[88:91], v[140:143], v[44:47]
    v_mfma_f32_16x16x32_bf16 v[48:51], v[120:123], v[140:143], v[48:51]
    s_and_b32 s9, s60, 3
    s_cbranch_scc0 Ls_mb_58
    s_barrier
Ls_mb_58:
    s_waitcnt lgkmcnt(9)
    v_mfma_f32_16x16x32_bf16 v[44:47], v[84:87], v[144:147], v[44:47]
    ds_read_b128 v[136:139], v3 offset:3200
    v_mfma_f32_16x16x32_bf16 v[48:51], v[116:119], v[144:147], v[48:51]
    s_waitcnt lgkmcnt(9)
    v_mfma_f32_16x16x32_bf16 v[44:47], v[80:83], v[148:151], v[44:47]
    ds_read_b128 v[140:143], v3 offset:3264
    v_mfma_f32_16x16x32_bf16 v[48:51], v[112:115], v[148:151], v[48:51]
    s_waitcnt lgkmcnt(9)
    v_mfma_f32_16x16x32_bf16 v[44:47], v[76:79], v[152:155], v[44:47]
    ds_read_b128 v[144:147], v3 offset:3328
    v_mfma_f32_16x16x32_bf16 v[48:51], v[108:111], v[152:155], v[48:51]
    s_waitcnt lgkmcnt(9)
    v_mfma_f32_16x16x32_bf16 v[44:47], v[72:75], v[156:159], v[44:47]
    ds_read_b128 v[148:151], v3 offset:3392
    v_mfma_f32_16x16x32_bf16 v[48:51], v[104:107], v[156:159], v[48:51]
    s_waitcnt lgkmcnt(9)
    v_mfma_f32_16x16x32_bf16 v[44:47], v[68:71], v[160:163], v[44:47]
    ds_read_b128 v[152:155], v3 offset:3456
    v_mfma_f32_16x16x32_bf16 v[48:51], v[100:103], v[160:163], v[48:51]
    s_waitcnt lgkmcnt(9)
    v_mfma_f32_16x16x32_bf16 v[44:47], v[64:67], v[164:167], v[44:47]
    ds_read_b128 v[156:159], v3 offset:3520
    v_mfma_f32_16x16x32_bf16 v[48:51], v[96:99], v[164:167], v[48:51]
    s_waitcnt lgkmcnt(9)
    v_mfma_f32_16x16x32_bf16 v[44:47], v[60:63], v[168:171], v[44:47]
    ds_read_b128 v[160:163], v3 offset:3584
    v_mfma_f32_16x16x32_bf16 v[48:51], v[92:95], v[168:171], v[48:51]
    s_waitcnt lgkmcnt(9)
    v_mfma_f32_16x16x32_bf16 v[44:47], v[56:59], v[172:175], v[44:47]
    ds_read_b128 v[164:167], v3 offset:3648
    v_mfma_f32_16x16x32_bf16 v[48:51], v[88:91], v[172:175], v[48:51]
    v_mfma_f32_16x16x32_bf16 v[52:55], v[120:123], v[172:175], v[52:55]
    s_and_b32 s9, s60, 3
    s_cbranch_scc1 Ls_mb_59
    s_barrier
Ls_mb_59:
    s_waitcnt lgkmcnt(9)
    v_mfma_f32_16x16x32_bf16 v[48:51], v[84:87], v[128:131], v[48:51]
    ds_read_b128 v[168:171], v3 offset:3712
    ds_read_b128 v[176:179], v4 offset:0
    ds_read_b128 v[180:183], v4 offset:1024
    v_mfma_f32_16x16x32_bf16 v[52:55], v[116:119], v[128:131], v[52:55]
    ds_read_b128 v[184:187], v4 offset:2048
    ds_read_b128 v[200:203], v4 offset:6144
    s_waitcnt lgkmcnt(13)
    v_mfma_f32_16x16x32_bf16 v[48:51], v[80:83], v[132:135], v[48:51]
    ds_read_b128 v[172:175], v3 offset:3776
    ds_read_b128 v[188:191], v4 offset:3072
    ds_read_b128 v[204:207], v4 offset:7168
    v_mfma_f32_16x16x32_bf16 v[52:55], v[112:115], v[132:135], v[52:55]
    ds_read_b128 v[192:195], v4 offset:4096
    ds_read_b128 v[208:211], v4 offset:8192
    s_waitcnt lgkmcnt(15)
    v_mfma_f32_16x16x32_bf16 v[48:51], v[76:79], v[136:139], v[48:51]
    ds_read_b128 v[128:131], v3 offset:3840
    ds_read_b128 v[196:199], v4 offset:5120
    ds_read_b128 v[212:215], v4 offset:9216
    v_mfma_f32_16x16x32_bf16 v[52:55], v[108:111], v[136:139], v[52:55]
    s_waitcnt lgkmcnt(11)
    v_add_f32 v32, v32, v176
    v_add_f32_e64 v33, v33, v177
    v_mfma_f32_16x16x32_bf16 v[48:51], v[72:75], v[140:143], v[48:51]
    ds_read_b128 v[132:135], v3 offset:3904
    v_add_f32 v34, v34, v178
    v_add_f32 v35, v35, v179
    v_mfma_f32_16x16x32_bf16 v[52:55], v[104:107], v[140:143], v[52:55]
    s_waitcnt lgkmcnt(11)
    v_add_f32 v36, v36, v180
    v_add_f32_e64 v37, v37, v181
    v_mfma_f32_16x16x32_bf16 v[48:51], v[68:71], v[144:147], v[48:51]
    ds_read_b128 v[136:139], v3 offset:3968
    v_add_f32 v38, v38, v182
    v_add_f32 v39, v39, v183
    v_mfma_f32_16x16x32_bf16 v[52:55], v[100:103], v[144:147], v[52:55]
    v_cvt_pk_bf16_f32 v32, v32, v33
    v_cvt_pk_bf16_f32 v33, v34, v35
    v_mfma_f32_16x16x32_bf16 v[48:51], v[64:67], v[148:151], v[48:51]
    ds_read_b128 v[140:143], v3 offset:4032
    v_cvt_pk_bf16_f32 v34, v36, v37
    v_cvt_pk_bf16_f32 v35, v38, v39
    v_mfma_f32_16x16x32_bf16 v[52:55], v[96:99], v[148:151], v[52:55]
    v_permlane16_swap_b32 v32, v34
    v_permlane16_swap_b32 v33, v35
    v_mfma_f32_16x16x32_bf16 v[48:51], v[60:63], v[152:155], v[48:51]
    s_waitcnt lgkmcnt(12)
    v_add_f32 v40, v40, v184
    v_add_f32 v41, v41, v185
    v_mfma_f32_16x16x32_bf16 v[52:55], v[92:95], v[152:155], v[52:55]
    v_add_f32 v42, v42, v186
    v_add_f32 v43, v43, v187
    v_mfma_f32_16x16x32_bf16 v[48:51], v[56:59], v[156:159], v[48:51]
    s_waitcnt lgkmcnt(11)
    v_add_f32 v40, v40, v200
    v_add_f32 v41, v41, v201
    v_mfma_f32_16x16x32_bf16 v[52:55], v[88:91], v[156:159], v[52:55]
    v_add_f32 v42, v42, v202
    v_add_f32 v43, v43, v203
    v_mfma_f32_16x16x32_bf16 v[52:55], v[84:87], v[160:163], v[52:55]
    s_waitcnt lgkmcnt(9)
    v_add_f32 v44, v44, v188
    v_add_f32 v45, v45, v189
    v_mfma_f32_16x16x32_bf16 v[52:55], v[80:83], v[164:167], v[52:55]
    v_add_f32 v46, v46, v190
    v_add_f32 v47, v47, v191
    v_mfma_f32_16x16x32_bf16 v[52:55], v[76:79], v[168:171], v[52:55]
    s_waitcnt lgkmcnt(8)
    v_add_f32 v44, v44, v204
    v_add_f32 v45, v45, v205
    v_mfma_f32_16x16x32_bf16 v[52:55], v[72:75], v[172:175], v[52:55]
    v_add_f32 v46, v46, v206
    v_add_f32_e64 v47, v47, v207
    s_waitcnt lgkmcnt(5)
    v_mfma_f32_16x16x32_bf16 v[52:55], v[68:71], v[128:131], v[52:55]
    v_cvt_pk_bf16_f32 v40, v40, v41
    v_cvt_pk_bf16_f32 v41, v42, v43
    s_waitcnt lgkmcnt(2)
    v_mfma_f32_16x16x32_bf16 v[52:55], v[64:67], v[132:135], v[52:55]
    v_cvt_pk_bf16_f32 v42, v44, v45
    v_cvt_pk_bf16_f32 v43, v46, v47
    s_waitcnt lgkmcnt(1)
    v_mfma_f32_16x16x32_bf16 v[52:55], v[60:63], v[136:139], v[52:55]
    v_permlane16_swap_b32 v40, v42
    v_permlane16_swap_b32 v41, v43
    s_waitcnt lgkmcnt(0)
    v_mfma_f32_16x16x32_bf16 v[52:55], v[56:59], v[140:143], v[52:55]
    v_add_f32 v192, v192, v208
    v_add_f32 v193, v193, v209
    v_add_f32 v194, v194, v210
    v_add_f32 v195, v195, v211
    v_add_f32 v196, v196, v212
    v_add_f32 v197, v197, v213
    v_add_f32 v198, v198, v214
    v_add_f32_e64 v199, v199, v215
    buffer_store_dwordx4 v[24:27], v18, s[52:55], s56 offen offset:0 sc1
    buffer_store_dwordx4 v[32:35], v18, s[52:55], s56 offen offset:1024 sc1
    buffer_store_dwordx4 v[40:43], v18, s[52:55], s56 offen offset:2048 sc1
    v_pk_add_f32 v[48:49], v[48:49], v[192:193]
    v_pk_add_f32 v[50:51], v[50:51], v[194:195]
    v_pk_add_f32 v[52:53], v[52:53], v[196:197]
    v_pk_add_f32 v[54:55], v[54:55], v[198:199]
    v_cvt_pk_bf16_f32 v48, v48, v49
    v_cvt_pk_bf16_f32 v49, v50, v51
    v_cvt_pk_bf16_f32 v50, v52, v53
    v_cvt_pk_bf16_f32 v51, v54, v55
    s_nop 0
    v_permlane16_swap_b32 v48, v50
    v_permlane16_swap_b32 v49, v51
    buffer_store_dwordx4 v[48:51], v18, s[52:55], s56 offen offset:3072 sc1
    s_mov_b32 s57, 132096
    s_and_b32 s9, s49, 3
    s_lshl_b32 s9, s9, 3
    s_lshr_b32 s11, s49, 2
    s_add_u32 s9, s9, s11
    s_mov_b32 s56, 4
    s_lshl_b32 s58, 0x55, s9
    s_barrier
    s_branch Ls_end_57
Ls_o7_41:
    v_add_u32 v37, 368640, v37
    v_subrev_u32 v254, 2457600, v37
    v_min_u32 v37, v37, v254
    global_load_dword v255, v37, s[36:37]
    s_branch Ls_b7_42
Ls_o7_43:
    s_mov_b32 s13, 32768
    s_waitcnt vmcnt(3)
    v_cmp_eq_u32 vcc, 0, v32
    s_cbranch_vccz Lfo_46
Lfl_45:
    s_waitcnt vmcnt(0)
    v_cmp_eq_u32 vcc, 0, v32
    s_cbranch_vccz Lfo_46
    global_load_dword v32, v30, s[44:45] sc1
    s_sub_u32 s13, s13, 1
    s_cmp_lg_u32 s13, 0
    s_cbranch_scc1 Lfl_45
Lfo_46:
    v_mov_b32 v21, 1
    s_bitcmp1_b32 s2, 0
    s_cselect_b32 exec_lo, 0xf0, 15
    s_mov_b32 exec_hi, 0
    global_atomic_add v31, v21, s[46:47] sc1
    s_mov_b64 exec, -1
    v_lshlrev_b32 v46, 2, v0
    v_add_u32 v46, L_tab_src-Ls_pc_36, v46
    global_load_dwordx2 v[34:35], v46, s[64:65]
    v_lshlrev_b32_e64 v46, 4, v1
    v_add_u32 v46, L_tab_band-Ls_pc_36+2048, v46
    global_load_dwordx4 v[200:203], v46, s[64:65] offset:-2048
    global_load_dwordx4 v[204:207], v46, s[64:65] offset:-1024
    global_load_dwordx4 v[208:211], v46, s[64:65] offset:0
    global_load_dwordx4 v[212:215], v46, s[64:65] offset:1024
    global_load_dwordx4 v[216:219], v46, s[64:65] offset:2048
    global_load_dwordx4 v[220:223], v46, s[64:65] offset:3072
    global_load_dword v255, v38, s[16:17] offset:384
    v_add_u32 v37, 368640, v37
    v_subrev_u32 v254, 2457600, v37
    v_min_u32_e64 v37, v37, v254
    global_load_dword v255, v37, s[36:37]
    global_load_dword v255, v33, s[36:37]
    v_add_u32 v33, 737280, v33
    v_subrev_u32 v254, 2457600, v33
    v_min_u32 v33, v33, v254
    s_branch Ls_b7_44
Ls_o7_47:
    v_mov_b32 v22, 0
    s_mov_b64 exec, 1
    global_atomic_add v21, v20, v22, s[46:47] sc0 sc1
    s_mov_b64 exec, -1
    global_load_dword v255, v33, s[36:37]
    v_add_u32 v33, 737280, v33
    v_subrev_u32 v254, 2457600, v33
    v_min_u32 v33, v33, v254
    global_load_dword v255, v33, s[36:37]
    v_add_u32 v33, 737280, v33
    v_subrev_u32 v254, 2457600, v33
    v_min_u32_e64 v33, v33, v254
    global_load_dword v255, v33, s[36:37]
    v_add_u32 v33, 737280, v33
    v_subrev_u32 v254, 2457600, v33
    v_min_u32 v33, v33, v254
    s_branch Ls_b7_48
Ls_dil_56:
    s_setprio 1
    v_mov_b32 v226, v37
    v_mov_b32 v227, v38
    v_mov_b32 v228, v39
    v_mov_b32 v229, v33
    v_lshl_add_u32 v16, v15, 3, v16
    v_lshlrev_b32 v19, 4, v1
    v_add_u32 v19, 0, v19
    s_cmp_eq_u32 s60, 6
    s_movk_i32 s56, 0x198
    s_cselect_b32 s56, 0x3ba, s56
    s_cmp_eq_u32 s60, 7
    s_cselect_b32 s56, 0x425c, s56
    s_mul_i32 s57, s60, 12
    s_add_u32 s57, s57, 9
    v_mul_u32_u24 v5, 26, v1
    v_lshrrev_b32 v5, 8, v5
    v_mul_u32_u24 v5, 1120, v5
    v_lshl_add_u32 v5, v1, 4, v5
    s_mul_i32 s8, s57, 7680
    s_mul_i32 s9, s62, 160
    s_add_u32 s8, s8, s9
    v_add_u32 v5, s8, v5
    s_mov_b32 s52, s38
    s_mov_b32 s53, s39
    s_mov_b32 s54, 819200
    s_mov_b32 s55, 0x20000
    s_mul_i32 s58, s57, 960
    s_add_u32 s58, s58, 51200
    s_waitcnt lgkmcnt(0)
    s_barrier
    s_cmp_lg_u32 s60, 7
    s_cbranch_scc1 Ls_w7_60
    v_min_u32 v228, 819196, v228
    global_load_dword v255, v228, s[38:39]
    v_add_u32 v228, 15360, v228
    v_min_u32 v228, 819196, v228
    global_load_dword v255, v228, s[38:39]
    v_add_u32 v228, 15360, v228
Ls_w7_60:
Ls_unit_61:
    s_bitcmp1_b32 s56, 3
    s_cselect_b32 s11, 8, 1
    s_and_b32 s9, s56, 15
    s_sub_u32 s9, s9, s11
    s_mul_i32 s12, s9, 8448
    v_add_u32 v2, s12, v16
    s_mul_i32 s12, s9, 4640
    v_add_u32 v3, s12, v17
    s_mul_i32 s12, s9, 10240
    v_add_u32_e64 v4, s12, v19
    s_add_u32 m0, s58, 0
    s_nop 0
    buffer_load_dwordx4 v5, s[52:55], 0 offen lds
    v_add_u32 v5, 7680, v5
    s_add_u32 m0, s58, 960
    s_nop 0
    buffer_load_dwordx4 v5, s[52:55], 0 offen lds
    v_add_u32 v5, 7680, v5
    s_add_u32 m0, s58, 1920
    s_nop 0
    buffer_load_dwordx4 v5, s[52:55], 0 offen lds
    v_add_u32 v5, 7680, v5
    s_add_u32 m0, s58, 2880
    s_nop 0
    buffer_load_dwordx4 v5, s[52:55], 0 offen lds
    v_add_u32 v5, 7680, v5
    s_add_u32 s58, s58, 3840
    s_cmp_eq_u32 s11, 1
    s_cbranch_scc1 Ls_u3_62
    ds_read_b128 v[48:51], v3 offset:432
    ds_read_b128 v[52:55], v3 offset:448
    ds_read_b128 v[56:59], v3 offset:944
    ds_read_b128 v[60:63], v3 offset:960
    ds_read_b128 v[64:67], v3 offset:1456
    ds_read_b128 v[68:71], v3 offset:1472
    s_waitcnt lgkmcnt(5)
    v_mfma_f32_16x16x32_bf16 v[96:99], v[48:51], v[200:203], 0
    ds_read_b64 v[24:25], v2 offset:1280
    ds_read_b64 v[26:27], v2 offset:1408
    s_waitcnt lgkmcnt(6)
    v_mfma_f32_16x16x32_bf16 v[100:103], v[52:55], v[204:207], 0
    ds_read_b64 v[28:29], v2 offset:1536
    ds_read_b64 v[30:31], v2 offset:1664
    v_mfma_f32_16x16x32_bf16 v[104:107], v[52:55], v[208:211], 0
    ds_read_b64 v[32:33], v2 offset:1248
    ds_read_b64 v[34:35], v2 offset:1376
    v_mfma_f32_16x16x32_bf16 v[108:111], v[52:55], v[212:215], 0
    ds_read_b64 v[36:37], v2 offset:1504
    ds_read_b64 v[38:39], v2 offset:1632
    s_waitcnt lgkmcnt(11)
    v_mfma_f32_16x16x32_bf16 v[112:115], v[56:59], v[200:203], 0
    ds_read_b64 v[40:41], v2 offset:1216
    ds_read_b64 v[42:43], v2 offset:1344
    s_waitcnt lgkmcnt(12)
    v_mfma_f32_16x16x32_bf16 v[116:119], v[60:63], v[204:207], 0
    s_nop 0
    ds_read_b64 v[44:45], v2 offset:1472
    ds_read_b64 v[46:47], v2 offset:1600
    v_mfma_f32_16x16x32_bf16 v[120:123], v[60:63], v[208:211], 0
    ds_read_b128 v[72:75], v3 offset:1968
    ds_read_b128 v[76:79], v3 offset:1984
    v_mfma_f32_16x16x32_bf16 v[124:127], v[60:63], v[212:215], 0
    ds_read_b128 v[80:83], v3 offset:2480
    ds_read_b128 v[84:87], v3 offset:2496
    v_cvt_pk_bf16_f32 v128, v96, v97
    v_cvt_pk_bf16_f32 v129, v98, v99
    v_cvt_pk_bf16_f32 v130, v100, v101
    v_cvt_pk_bf16_f32 v131, v102, v103
    v_cvt_pk_bf16_f32 v132, v104, v105
    v_cvt_pk_bf16_f32 v133, v106, v107
    v_cvt_pk_bf16_f32 v134, v108, v109
    v_cvt_pk_bf16_f32 v135, v110, v111
    s_waitcnt lgkmcnt(14)
    v_mfma_f32_16x16x32_bf16 v[144:147], v[128:131], v[24:27], 0
    ds_read_b128 v[88:91], v3 offset:2992
    ds_read_b128 v[92:95], v3 offset:3008
    v_cvt_pk_bf16_f32 v136, v112, v113
    v_cvt_pk_bf16_f32 v137, v114, v115
    s_waitcnt lgkmcnt(12)
    v_mfma_f32_16x16x32_bf16 v[148:151], v[128:131], v[32:35], 0
    v_cvt_pk_bf16_f32 v138, v116, v117
    v_cvt_pk_bf16_f32 v139, v118, v119
    s_waitcnt lgkmcnt(8)
    s_nop 0
    v_mfma_f32_16x16x32_bf16 v[152:155], v[128:131], v[40:43], 0
    v_cvt_pk_bf16_f32 v140, v120, v121
    v_cvt_pk_bf16_f32 v141, v122, v123
    v_mfma_f32_16x16x32_bf16 v[144:147], v[132:135], v[28:31], v[144:147]
    v_cvt_pk_bf16_f32 v142, v124, v125
    v_cvt_pk_bf16_f32 v143, v126, v127
    v_mfma_f32_16x16x32_bf16 v[148:151], v[132:135], v[36:39], v[148:151]
    s_waitcnt lgkmcnt(6)
    v_mfma_f32_16x16x32_bf16 v[152:155], v[132:135], v[44:47], v[152:155]
    v_mfma_f32_16x16x32_bf16 v[96:99], v[64:67], v[200:203], 0
    v_mfma_f32_16x16x32_bf16 v[100:103], v[68:71], v[204:207], 0
    v_mfma_f32_16x16x32_bf16 v[104:107], v[68:71], v[208:211], 0
    v_mfma_f32_16x16x32_bf16 v[108:111], v[68:71], v[212:215], 0
    v_mfma_f32_16x16x32_bf16 v[148:151], v[136:139], v[24:27], v[148:151]
    s_nop 3
    v_cvt_pk_bf16_f32 v128, v96, v97
    v_cvt_pk_bf16_f32 v129, v98, v99
    v_mfma_f32_16x16x32_bf16 v[152:155], v[136:139], v[32:35], v[152:155]
    v_cvt_pk_bf16_f32 v130, v100, v101
    v_cvt_pk_bf16_f32 v131, v102, v103
    v_mfma_f32_16x16x32_bf16 v[156:159], v[136:139], v[40:43], 0
    v_cvt_pk_bf16_f32 v132, v104, v105
    v_cvt_pk_bf16_f32 v133, v106, v107
    v_mfma_f32_16x16x32_bf16 v[148:151], v[140:143], v[28:31], v[148:151]
    v_cvt_pk_bf16_f32 v134, v108, v109
    v_cvt_pk_bf16_f32 v135, v110, v111
    v_mfma_f32_16x16x32_bf16 v[152:155], v[140:143], v[36:39], v[152:155]
    v_mfma_f32_16x16x32_bf16 v[156:159], v[140:143], v[44:47], v[156:159]
    s_waitcnt lgkmcnt(5)
    v_mfma_f32_16x16x32_bf16 v[112:115], v[72:75], v[200:203], 0
    s_waitcnt lgkmcnt(4)
    v_mfma_f32_16x16x32_bf16 v[116:119], v[76:79], v[204:207], 0
    v_mfma_f32_16x16x32_bf16 v[120:123], v[76:79], v[208:211], 0
    v_mfma_f32_16x16x32_bf16 v[124:127], v[76:79], v[212:215], 0
    ds_write_b128 v4, v[144:147] offset:0
    v_mfma_f32_16x16x32_bf16 v[152:155], v[128:131], v[24:27], v[152:155]
    s_nop 1
    s_nop 0
    v_cvt_pk_bf16_f32 v136, v112, v113
    v_cvt_pk_bf16_f32 v137, v114, v115
    v_mfma_f32_16x16x32_bf16 v[156:159], v[128:131], v[32:35], v[156:159]
    v_cvt_pk_bf16_f32 v138, v116, v117
    v_cvt_pk_bf16_f32 v139, v118, v119
    v_mfma_f32_16x16x32_bf16 v[160:163], v[128:131], v[40:43], 0
    v_cvt_pk_bf16_f32 v140, v120, v121
    v_cvt_pk_bf16_f32 v141, v122, v123
    v_mfma_f32_16x16x32_bf16 v[152:155], v[132:135], v[28:31], v[152:155]
    v_cvt_pk_bf16_f32 v142, v124, v125
    v_cvt_pk_bf16_f32 v143, v126, v127
    v_mfma_f32_16x16x32_bf16 v[156:159], v[132:135], v[36:39], v[156:159]
    v_mfma_f32_16x16x32_bf16 v[160:163], v[132:135], v[44:47], v[160:163]
    s_waitcnt lgkmcnt(4)
    v_mfma_f32_16x16x32_bf16 v[96:99], v[80:83], v[200:203], 0
    s_waitcnt lgkmcnt(3)
    v_mfma_f32_16x16x32_bf16 v[100:103], v[84:87], v[204:207], 0
    v_mfma_f32_16x16x32_bf16 v[104:107], v[84:87], v[208:211], 0
    v_mfma_f32_16x16x32_bf16 v[108:111], v[84:87], v[212:215], 0
    ds_write_b128 v4, v[148:151] offset:1024
    v_mfma_f32_16x16x32_bf16 v[156:159], v[136:139], v[24:27], v[156:159]
    s_nop 1
    s_nop 0
    v_cvt_pk_bf16_f32 v128, v96, v97
    v_cvt_pk_bf16_f32 v129, v98, v99
    v_mfma_f32_16x16x32_bf16 v[160:163], v[136:139], v[32:35], v[160:163]
    v_cvt_pk_bf16_f32 v130, v100, v101
    v_cvt_pk_bf16_f32 v131, v102, v103
    v_mfma_f32_16x16x32_bf16 v[164:167], v[136:139], v[40:43], 0
    v_cvt_pk_bf16_f32 v132, v104, v105
    v_cvt_pk_bf16_f32 v133, v106, v107
    v_mfma_f32_16x16x32_bf16 v[156:159], v[140:143], v[28:31], v[156:159]
    v_cvt_pk_bf16_f32 v134, v108, v109
    v_cvt_pk_bf16_f32 v135, v110, v111
    v_mfma_f32_16x16x32_bf16 v[160:163], v[140:143], v[36:39], v[160:163]
    v_mfma_f32_16x16x32_bf16 v[164:167], v[140:143], v[44:47], v[164:167]
    s_waitcnt lgkmcnt(3)
    v_mfma_f32_16x16x32_bf16 v[112:115], v[88:91], v[200:203], 0
    s_waitcnt lgkmcnt(2)
    v_mfma_f32_16x16x32_bf16 v[116:119], v[92:95], v[204:207], 0
    v_mfma_f32_16x16x32_bf16 v[120:123], v[92:95], v[208:211], 0
    v_mfma_f32_16x16x32_bf16 v[124:127], v[92:95], v[212:215], 0
    ds_write_b128 v4, v[152:155] offset:2048
    v_mfma_f32_16x16x32_bf16 v[160:163], v[128:131], v[24:27], v[160:163]
    s_nop 1
    s_nop 0
    v_cvt_pk_bf16_f32 v136, v112, v113
    v_cvt_pk_bf16_f32 v137, v114, v115
    v_mfma_f32_16x16x32_bf16 v[164:167], v[128:131], v[32:35], v[164:167]
    v_cvt_pk_bf16_f32 v138, v116, v117
    v_cvt_pk_bf16_f32 v139, v118, v119
    v_mfma_f32_16x16x32_bf16 v[160:163], v[132:135], v[28:31], v[160:163]
    v_cvt_pk_bf16_f32 v140, v120, v121
    v_cvt_pk_bf16_f32 v141, v122, v123
    v_mfma_f32_16x16x32_bf16 v[164:167], v[132:135], v[36:39], v[164:167]
    v_cvt_pk_bf16_f32 v142, v124, v125
    v_cvt_pk_bf16_f32 v143, v126, v127
    ds_write_b128 v4, v[156:159] offset:3072
    v_mfma_f32_16x16x32_bf16 v[164:167], v[136:139], v[24:27], v[164:167]
    v_mfma_f32_16x16x32_bf16 v[164:167], v[140:143], v[28:31], v[164:167]
    ds_write_b128 v4, v[160:163] offset:4096
    s_nop 6
    ds_write_b128 v4, v[164:167] offset:5120
    s_cmp_lg_u32 s60, 7
    s_cbranch_scc1 Ls_w7_64
Ls_w7_64:
    s_branch Ls_un_63
Ls_u3_62:
    ds_read_b128 v[48:51], v3 offset:432
    ds_read_b128 v[52:55], v3 offset:448
    ds_read_b128 v[56:59], v3 offset:944
    ds_read_b128 v[60:63], v3 offset:960
    ds_read_b128 v[64:67], v3 offset:1456
    ds_read_b128 v[68:71], v3 offset:1472
    s_waitcnt lgkmcnt(5)
    v_mfma_f32_16x16x32_bf16 v[96:99], v[48:51], v[216:219], 0
    ds_read_b64 v[24:25], v2 offset:1824
    ds_read_b64 v[26:27], v2 offset:1984
    s_waitcnt lgkmcnt(6)
    v_mfma_f32_16x16x32_bf16 v[100:103], v[52:55], v[220:223], 0
    ds_read_b64 v[28:29], v2 offset:1792
    ds_read_b64 v[30:31], v2 offset:1952
    s_waitcnt lgkmcnt(7)
    v_mfma_f32_16x16x32_bf16 v[112:115], v[56:59], v[216:219], 0
    ds_read_b64 v[32:33], v2 offset:1760
    ds_read_b64 v[34:35], v2 offset:1920
    s_waitcnt lgkmcnt(8)
    v_mfma_f32_16x16x32_bf16 v[116:119], v[60:63], v[220:223], 0
    ds_read_b64 v[36:37], v2 offset:1728
    ds_read_b64 v[38:39], v2 offset:1888
    v_cvt_pk_bf16_f32 v128, v96, v97
    v_cvt_pk_bf16_f32 v129, v98, v99
    v_cvt_pk_bf16_f32 v130, v100, v101
    v_cvt_pk_bf16_f32 v131, v102, v103
    s_waitcnt lgkmcnt(6)
    s_nop 0
    v_mfma_f32_16x16x32_bf16 v[144:147], v[128:131], v[24:27], 0
    ds_read_b128 v[72:75], v3 offset:1968
    ds_read_b128 v[76:79], v3 offset:1984
    v_cvt_pk_bf16_f32 v136, v112, v113
    v_cvt_pk_bf16_f32 v137, v114, v115
    s_waitcnt lgkmcnt(6)
    v_mfma_f32_16x16x32_bf16 v[148:151], v[128:131], v[28:31], 0
    v_cvt_pk_bf16_f32 v138, v116, v117
    v_cvt_pk_bf16_f32 v139, v118, v119
    s_waitcnt lgkmcnt(4)
    v_mfma_f32_16x16x32_bf16 v[152:155], v[128:131], v[32:35], 0
    s_waitcnt lgkmcnt(2)
    v_mfma_f32_16x16x32_bf16 v[156:159], v[128:131], v[36:39], 0
    v_mfma_f32_16x16x32_bf16 v[96:99], v[64:67], v[216:219], 0
    v_mfma_f32_16x16x32_bf16 v[100:103], v[68:71], v[220:223], 0
    v_mfma_f32_16x16x32_bf16 v[148:151], v[136:139], v[24:27], v[148:151]
    s_nop 5
    v_cvt_pk_bf16_f32 v128, v96, v97
    v_cvt_pk_bf16_f32 v129, v98, v99
    v_mfma_f32_16x16x32_bf16 v[152:155], v[136:139], v[28:31], v[152:155]
    v_cvt_pk_bf16_f32 v130, v100, v101
    v_cvt_pk_bf16_f32 v131, v102, v103
    v_mfma_f32_16x16x32_bf16 v[156:159], v[136:139], v[32:35], v[156:159]
    s_waitcnt lgkmcnt(1)
    v_mfma_f32_16x16x32_bf16 v[112:115], v[72:75], v[216:219], 0
    s_waitcnt lgkmcnt(0)
    v_mfma_f32_16x16x32_bf16 v[116:119], v[76:79], v[220:223], 0
    ds_write_b128 v4, v[144:147] offset:6144
    v_mfma_f32_16x16x32_bf16 v[152:155], v[128:131], v[24:27], v[152:155]
    s_nop 3
    s_nop 0
    v_cvt_pk_bf16_f32 v136, v112, v113
    v_cvt_pk_bf16_f32 v137, v114, v115
    v_mfma_f32_16x16x32_bf16 v[156:159], v[128:131], v[28:31], v[156:159]
    v_cvt_pk_bf16_f32 v138, v116, v117
    v_cvt_pk_bf16_f32 v139, v118, v119
    ds_write_b128 v4, v[148:151] offset:7168
    s_nop 0
    v_mfma_f32_16x16x32_bf16 v[156:159], v[136:139], v[24:27], v[156:159]
    ds_write_b128 v4, v[152:155] offset:8192
    s_nop 6
    ds_write_b128 v4, v[156:159] offset:9216
Ls_un_63:
    s_lshr_b32 s56, s56, 4
    s_cbranch_scc1 Ls_unit_61
    s_sub_u32 s57, s60, 5
    v_mul_u32_u24 v2, 26, v1
    v_lshrrev_b32_e64 v2, 8, v2
    v_mul_u32_u24 v2, 1120, v2
    v_lshl_add_u32 v2, v1, 4, v2
    s_mul_i32 s8, s57, 7680
    s_mul_i32 s9, s62, 160
    s_add_u32 s8, s8, s9
    v_add_u32 v2, s8, v2
    s_mov_b32 s52, s38
    s_mov_b32 s53, s39
    s_mov_b32 s54, 819200
    s_mov_b32 s55, 0x20000
    s_mul_i32 s56, s57, 960
    s_add_u32 s56, s56, 51200
    s_waitcnt lgkmcnt(0)
    s_barrier
    s_setprio 0
    s_mov_b32 s57, 0
    s_add_u32 s13, s57, 322560
Ls_wo_65:
    s_mov_b32 m0, s56
    s_add_u32 s56, s56, 2880
    buffer_load_dwordx4 v2, s[52:55], s57 offen lds
    s_add_u32 s57, s57, 23040
    s_cmp_lg_u32 s57, s13
    s_cbranch_scc1 Ls_wo_65
    s_barrier
    s_add_u32 s13, s57, 207360
Ls_wo_66:
    s_mov_b32 m0, s56
    s_add_u32 s56, s56, 2880
    buffer_load_dwordx4 v2, s[52:55], s57 offen lds
    s_add_u32 s57, s57, 23040
    s_cmp_lg_u32 s57, s13
    s_cbranch_scc1 Ls_wo_66
    v_mov_b32 v6, 163820
    v_mov_b32 v7, 1
    s_mov_b64 exec, 1
    ds_add_u32 v6, v7
    s_mov_b64 exec, -1
    s_mov_b32 s56, 0
Ls_end_57:
    s_mov_b32 s59, 7
L_p2:
    s_and_b32 s61, s2, 6
    s_lshl_b32 s61, s61, 2
    s_lshr_b32 s4, s2, 5
    s_add_u32 s61, s61, s4
    s_and_b32 s7, s2, 31
    s_lshl_b32 s7, s7, 11
    s_add_u32 s63, s7, 132096
    s_bfe_u32 s8, s2, 0x20006
    s_lshl_b32 s8, s8, 8
    s_add_u32 s7, s7, s8
    s_add_u32 s7, s7, 131072
    v_mov_b32 v122, 163832
    v_mov_b32 v121, s63
    v_writelane_b32 v121, s7, 0
    v_mov_b32 v123, 0
    s_and_b32 s4, s60, 3
    s_lshr_b32 s5, s60, 2
    v_lshlrev_b32 v2, 4, v0
    v_add_u32 v2, 153600, v2
    v_and_b32 v6, 15, v1
    v_lshrrev_b32 v7, 5, v1
    v_lshrrev_b32_e64 v20, 4, v1
    s_lshl_b32 s6, s61, 1
    s_lshr_b32 s7, s4, 1
    s_add_u32 s6, s6, s7
    s_mul_i32 s7, s6, 40960
    s_mul_i32 s8, s5, 20480
    s_add_u32 s7, s7, s8
    s_and_b32 s8, s4, 1
    s_lshl_b32 s8, s8, 8
    s_add_u32 s7, s7, s8
    s_add_u32 s7, s7, 1052672
    v_lshl_add_u32 v3, v6, 4, s7
    v_lshl_add_u32 v3, v20, 9, v3
    v_add_u32 v4, 8192, v3
    v_add_u32 v13, 16384, v3
    s_lshl_b32 s7, s61, 8
    s_lshl_b32 s8, s4, 6
    s_add_u32 s7, s7, s8
    s_add_u32 s7, s7, 65536
    v_lshl_add_u32 v8, v20, 4, s7
    v_lshrrev_b32 v10, 3, v1
    s_lshl_b32 s7, s60, 2
    v_add_u32 v11, s7, v20
    v_xor_b32 v11, v11, v1
    v_and_b32 v11, 7, v11
    v_lshlrev_b32_e64 v11, 4, v11
    v_lshl_add_u32 v10, v10, 12, v11
    s_mul_i32 s7, s62, 327680
    s_lshl_b32 s8, s61, 7
    s_add_u32 s7, s7, s8
    s_add_u32 s7, s7, 4194304
    s_lshl_b32 s8, s60, 15
    s_add_u32 s8, s8, s7
    v_add_u32 v5, s8, v10
    v_add_u32 v9, 0x40000, v5
    v_and_b32 v21, 3, v1
    v_bfe_u32 v16, v1, 2, 2
    v_and_b32_e64 v17, 1, v20
    v_lshl_add_u32 v16, v16, 1, v17
    v_lshl_add_u32 v16, v7, 4, v16
    v_mul_u32_u24 v16, 160, v16
    v_lshl_add_u32 v16, v21, 3, v16
    s_mul_i32 s7, s5, 51200
    s_add_u32 s7, s7, 51200
    v_add_u32 v15, s7, v16
    s_lshl_b32 s7, s4, 1
    v_add_u32 v16, s7, v7
    v_lshrrev_b32 v18, 1, v6
    v_xor_b32 v16, v16, v18
    v_lshlrev_b32 v16, 4, v16
    v_lshl_add_u32 v16, v6, 7, v16
    v_lshl_add_u32 v16, v17, 3, v16
    v_add_u32 v10, 153600, v16
    v_mov_b32 v116, 163836
    v_mov_b32 v117, 1
    v_lshl_add_u32 v119, v1, 11, s57
    s_waitcnt vmcnt(0)
    s_cmp_eq_u32 s56, 0
    s_cbranch_scc1 Lsg_67
    s_mov_b64 exec, 1
    ds_add_rtn_u32 v118, v116, v117
    s_waitcnt lgkmcnt(0)
    v_cmp_eq_u32 vcc, s56, v118
    s_cbranch_vccz Lsg_67
    s_mov_b32 exec_lo, s58
    global_atomic_add v119, v117, s[46:47] sc1
Lsg_67:
    s_mov_b64 exec, -1
    v_lshrrev_b32 v17, 3, v0
    v_and_b32 v18, 7, v0
    v_mul_u32_u24 v19, 1280, v17
    v_lshl_add_u32 v112, v18, 4, v19
    s_lshl_b32 s8, s60, 7
    v_and_b32 v16, 3, v17
    v_mul_u32_u24 v19, 2176, v16
    v_lshl_add_u32 v19, v7, 6, v19
    v_lshrrev_b32_e64 v16, 1, v18
    v_mul_u32_u24 v16, 8720, v16
    v_add3_u32 v19, v19, v16, s8
    v_lshrrev_b32 v16, 2, v18
    v_and_b32 v18, 1, v18
    v_add_u32_e64 v16, v16, v18
    v_lshl_add_u32 v113, v16, 5, v19
    v_bfe_u32 v17, v1, 2, 3
    v_mul_u32_u24 v19, 1280, v17
    v_lshl_add_u32 v19, v21, 3, v19
    s_mul_i32 s7, s60, 10240
    s_add_u32 s7, s7, 128
    v_add_u32 v114, s7, v19
    v_and_b32 v16, 3, v17
    v_mul_u32_u24 v19, 2176, v16
    v_lshrrev_b32_e64 v16, 2, v17
    v_lshl_add_u32 v19, v16, 6, v19
    v_lshl_add_u32 v19, v21, 4, v19
    v_add_u32_e64 v115, s8, v19
    s_mov_b32 s48, s42
    s_mov_b32 s49, s43
    s_mov_b32 s50, 2621440
    s_mov_b32 s51, 0x20000
    s_cmp_lg_u32 s60, s59
    s_cbranch_scc1 Lp_w1_68
    v_mov_b32_e64 v120, 16
    v_writelane_b32 v120, 8, 0
    v_mov_b32 v16, 163820
Lp_w1w_72:
    ds_read_b32 v17, v16
    s_waitcnt lgkmcnt(0)
    v_cmp_ne_u32 vcc, 3, v17
    s_cbranch_vccnz Lp_w1w_72
    s_mov_b32 s13, 32768
    s_mov_b64 exec, 3
    global_atomic_add v255, v121, v123, s[46:47] sc0 sc1
Lp_w1p_69:
    global_atomic_add v254, v121, v123, s[46:47] sc0 sc1
    s_waitcnt vmcnt(1)
    v_cmp_eq_u32 vcc, v120, v255
    s_cbranch_vccnz Lp_w1e_70
    global_atomic_add v255, v121, v123, s[46:47] sc0 sc1
    s_waitcnt vmcnt(1)
    v_cmp_eq_u32 vcc, v120, v254
    s_cbranch_vccnz Lp_w1f_71
    s_sub_u32 s13, s13, 1
    s_cbranch_scc0 Lp_w1p_69
Lp_w1e_70:
    s_cmp_lg_u32 vcc_lo, 2
    s_cbranch_scc1 Lp_w1f_71
    global_atomic_add v255, v121, v123, s[46:47] sc0 sc1
    s_waitcnt vmcnt(1)
    v_cmp_eq_u32 vcc, v120, v254
Lp_w1f_71:
    s_nop 1
    v_mov_b32 v17, vcc_lo
    ds_write_b32 v122, v17
    s_mov_b64 exec, -1
    s_waitcnt lgkmcnt(0)
Lp_w1_68:
    s_barrier
    ds_read_b32 v111, v122
    s_waitcnt lgkmcnt(0)
    v_readfirstlane_b32 s14, v111
    s_mov_b32 s15, 0
    s_bitcmp1_b32 s14, 0
    s_cbranch_scc1 Lp_go_73
    s_cmp_eq_u32 s60, s59
    s_cbranch_scc1 Lp_pl_74
    s_bitcmp0_b32 s14, 1
    s_cbranch_scc1 Lp_ye_76
    s_cmp_ge_u32 s60, 2
    s_cbranch_scc1 Lp_y2_77
    global_load_dwordx4 v[100:103], v9, s[46:47] sc1
Lp_y2_77:
    global_load_dwordx4 v[96:99], v5, s[46:47] sc1
Lp_ye_76:
    ds_read_b64_tr_b16 v[124:125], v15 offset:0
    ds_read_b64_tr_b16 v[126:127], v15 offset:1280
    ds_read_b64_tr_b16 v[128:129], v15 offset:32
    ds_read_b64_tr_b16 v[130:131], v15 offset:1312
    ds_read_b64_tr_b16 v[132:133], v15 offset:64
    ds_read_b64_tr_b16 v[134:135], v15 offset:1344
    ds_read_b64_tr_b16 v[136:137], v15 offset:96
    ds_read_b64_tr_b16 v[138:139], v15 offset:1376
    ds_read_b64_tr_b16 v[140:141], v15 offset:128
    ds_read_b64_tr_b16 v[142:143], v15 offset:1408
    ds_read_b64_tr_b16 v[144:145], v15 offset:5120
    ds_read_b64_tr_b16 v[146:147], v15 offset:6400
    ds_read_b64_tr_b16 v[148:149], v15 offset:5152
    ds_read_b64_tr_b16 v[150:151], v15 offset:6432
    ds_read_b64_tr_b16 v[152:153], v15 offset:5184
    ds_read_b64_tr_b16 v[154:155], v15 offset:6464
    ds_read_b64_tr_b16 v[156:157], v15 offset:5216
    ds_read_b64_tr_b16 v[158:159], v15 offset:6496
    ds_read_b64_tr_b16 v[160:161], v15 offset:5248
    ds_read_b64_tr_b16 v[162:163], v15 offset:6528
    ds_read_b64_tr_b16 v[164:165], v15 offset:10240
    ds_read_b64_tr_b16 v[166:167], v15 offset:11520
    ds_read_b64_tr_b16 v[168:169], v15 offset:10272
    ds_read_b64_tr_b16 v[170:171], v15 offset:11552
    ds_read_b64_tr_b16 v[172:173], v15 offset:10304
    ds_read_b64_tr_b16 v[174:175], v15 offset:11584
    ds_read_b64_tr_b16 v[176:177], v15 offset:10336
    ds_read_b64_tr_b16 v[178:179], v15 offset:11616
    ds_read_b64_tr_b16 v[180:181], v15 offset:10368
    ds_read_b64_tr_b16 v[182:183], v15 offset:11648
    s_mov_b32 s15, 1
    s_branch Lp_b_75
Lp_pl_74:
    s_mov_b32 s13, 32768
    s_mov_b64 exec, 1
Lp2_78:
    global_atomic_add v254, v121, v123, s[46:47] sc0 sc1
    s_waitcnt vmcnt(1)
    v_cmp_ne_u32 vcc, 8, v255
    s_nop 0
    s_and_b32 s12, vcc_lo, 1
    s_cbranch_scc0 Lp2e_79
    global_atomic_add v255, v121, v123, s[46:47] sc0 sc1
    s_sub_u32 s13, s13, 1
    s_cselect_b32 s12, 0, 1
    s_waitcnt vmcnt(1)
    v_cmp_ne_u32_e64 vcc, 8, v254
    s_nop 0
    s_and_b32 s12, s12, vcc_lo
    s_cbranch_scc1 Lp2_78
Lp2e_79:
    s_mov_b64 exec, -1
Lp_b_75:
    s_barrier
Lp_go_73:
    global_load_dwordx4 v[16:19], v3, s[46:47] offset:-4096 sc1
    global_load_dwordx4 v[20:23], v3, s[46:47] offset:-2048 sc1
    s_barrier
    s_bitcmp1_b32 s14, 1
    s_cbranch_scc1 Lp_yk_80
    s_mov_b64 exec, 2
    global_atomic_add v108, v121, v123, s[46:47] sc0 sc1
    s_mov_b64 exec, -1
Lp_yk_80:
    s_cmp_eq_u32 s15, 1
    s_cbranch_scc1 Lp_t_81
    s_bitcmp0_b32 s14, 1
    s_cbranch_scc1 Lp_ye_82
    s_cmp_ge_u32 s60, 2
    s_cbranch_scc1 Lp_y2_83
    global_load_dwordx4 v[100:103], v9, s[46:47] sc1
Lp_y2_83:
    global_load_dwordx4 v[96:99], v5, s[46:47] sc1
Lp_ye_82:
    ds_read_b64_tr_b16 v[124:125], v15 offset:0
    ds_read_b64_tr_b16 v[126:127], v15 offset:1280
    ds_read_b64_tr_b16 v[128:129], v15 offset:32
    ds_read_b64_tr_b16 v[130:131], v15 offset:1312
    ds_read_b64_tr_b16 v[132:133], v15 offset:64
    ds_read_b64_tr_b16 v[134:135], v15 offset:1344
    ds_read_b64_tr_b16 v[136:137], v15 offset:96
    ds_read_b64_tr_b16 v[138:139], v15 offset:1376
    ds_read_b64_tr_b16 v[140:141], v15 offset:128
    ds_read_b64_tr_b16 v[142:143], v15 offset:1408
    ds_read_b64_tr_b16 v[144:145], v15 offset:5120
    ds_read_b64_tr_b16 v[146:147], v15 offset:6400
    ds_read_b64_tr_b16 v[148:149], v15 offset:5152
    ds_read_b64_tr_b16 v[150:151], v15 offset:6432
    ds_read_b64_tr_b16 v[152:153], v15 offset:5184
    ds_read_b64_tr_b16 v[154:155], v15 offset:6464
    ds_read_b64_tr_b16 v[156:157], v15 offset:5216
    ds_read_b64_tr_b16 v[158:159], v15 offset:6496
    ds_read_b64_tr_b16 v[160:161], v15 offset:5248
    ds_read_b64_tr_b16 v[162:163], v15 offset:6528
    ds_read_b64_tr_b16 v[164:165], v15 offset:10240
    ds_read_b64_tr_b16 v[166:167], v15 offset:11520
    ds_read_b64_tr_b16 v[168:169], v15 offset:10272
    ds_read_b64_tr_b16 v[170:171], v15 offset:11552
    ds_read_b64_tr_b16 v[172:173], v15 offset:10304
    ds_read_b64_tr_b16 v[174:175], v15 offset:11584
    ds_read_b64_tr_b16 v[176:177], v15 offset:10336
    ds_read_b64_tr_b16 v[178:179], v15 offset:11616
    ds_read_b64_tr_b16 v[180:181], v15 offset:10368
    ds_read_b64_tr_b16 v[182:183], v15 offset:11648
Lp_t_81:
    ds_read_b64_tr_b16 v[184:185], v15 offset:15360
    ds_read_b64_tr_b16 v[186:187], v15 offset:16640
    ds_read_b64_tr_b16 v[188:189], v15 offset:15392
    ds_read_b64_tr_b16 v[190:191], v15 offset:16672
    ds_read_b64_tr_b16 v[192:193], v15 offset:15424
    ds_read_b64_tr_b16 v[194:195], v15 offset:16704
    ds_read_b64_tr_b16 v[196:197], v15 offset:15456
    ds_read_b64_tr_b16 v[198:199], v15 offset:16736
    ds_read_b64_tr_b16 v[200:201], v15 offset:15488
    ds_read_b64_tr_b16 v[202:203], v15 offset:16768
    ds_read_b64_tr_b16 v[204:205], v15 offset:20480
    ds_read_b64_tr_b16 v[206:207], v15 offset:21760
    ds_read_b64_tr_b16 v[208:209], v15 offset:20512
    ds_read_b64_tr_b16 v[210:211], v15 offset:21792
    ds_read_b64_tr_b16 v[212:213], v15 offset:20544
    ds_read_b64_tr_b16 v[214:215], v15 offset:21824
    ds_read_b64_tr_b16 v[216:217], v15 offset:20576
    ds_read_b64_tr_b16 v[218:219], v15 offset:21856
    ds_read_b64_tr_b16 v[220:221], v15 offset:20608
    ds_read_b64_tr_b16 v[222:223], v15 offset:21888
    ds_read_b64_tr_b16 v[224:225], v15 offset:25600
    ds_read_b64_tr_b16 v[226:227], v15 offset:26880
    ds_read_b64_tr_b16 v[228:229], v15 offset:25632
    ds_read_b64_tr_b16 v[230:231], v15 offset:26912
    ds_read_b64_tr_b16 v[232:233], v15 offset:25664
    ds_read_b64_tr_b16 v[234:235], v15 offset:26944
    ds_read_b64_tr_b16 v[236:237], v15 offset:25696
    ds_read_b64_tr_b16 v[238:239], v15 offset:26976
    ds_read_b64_tr_b16 v[240:241], v15 offset:25728
    ds_read_b64_tr_b16 v[242:243], v15 offset:27008
    ds_read_b64_tr_b16 v[244:245], v15 offset:30720
    ds_read_b64_tr_b16 v[246:247], v15 offset:32000
    ds_read_b64_tr_b16 v[248:249], v15 offset:30752
    ds_read_b64_tr_b16 v[250:251], v15 offset:32032
    global_load_dwordx4 v[24:27], v3, s[46:47] offset:0 sc1
    global_load_dwordx4 v[28:31], v3, s[46:47] offset:2048 sc1
    s_waitcnt vmcnt(3)
    s_waitcnt lgkmcnt(15)
    v_mfma_f32_16x16x32_bf16 v[56:59], v[16:19], v[124:127], 0
    v_mfma_f32_16x16x32_bf16 v[60:63], v[16:19], v[128:131], 0
    ds_read_b64_tr_b16 v[124:125], v15 offset:30784
    ds_read_b64_tr_b16 v[126:127], v15 offset:32064
    v_mfma_f32_16x16x32_bf16 v[64:67], v[16:19], v[132:135], 0
    ds_read_b64_tr_b16 v[128:129], v15 offset:30816
    ds_read_b64_tr_b16 v[130:131], v15 offset:32096
    v_mfma_f32_16x16x32_bf16 v[68:71], v[16:19], v[136:139], 0
    ds_read_b64_tr_b16 v[132:133], v15 offset:30848
    ds_read_b64_tr_b16 v[134:135], v15 offset:32128
    v_mfma_f32_16x16x32_bf16 v[72:75], v[16:19], v[140:143], 0
    ds_read_b64_tr_b16 v[136:137], v15 offset:35840
    ds_read_b64_tr_b16 v[138:139], v15 offset:37120
    global_load_dwordx4 v[32:35], v4, s[46:47] offset:-4096 sc1
    s_waitcnt vmcnt(3)
    v_mfma_f32_16x16x32_bf16 v[56:59], v[20:23], v[144:147], v[56:59]
    ds_read_b64_tr_b16 v[140:141], v15 offset:35872
    ds_read_b64_tr_b16 v[142:143], v15 offset:37152
    v_mfma_f32_16x16x32_bf16 v[60:63], v[20:23], v[148:151], v[60:63]
    ds_read_b64_tr_b16 v[144:145], v15 offset:35904
    ds_read_b64_tr_b16 v[146:147], v15 offset:37184
    v_mfma_f32_16x16x32_bf16 v[64:67], v[20:23], v[152:155], v[64:67]
    ds_read_b64_tr_b16 v[148:149], v15 offset:35936
    ds_read_b64_tr_b16 v[150:151], v15 offset:37216
    v_mfma_f32_16x16x32_bf16 v[68:71], v[20:23], v[156:159], v[68:71]
    ds_read_b64_tr_b16 v[152:153], v15 offset:35968
    ds_read_b64_tr_b16 v[154:155], v15 offset:37248
    v_mfma_f32_16x16x32_bf16 v[72:75], v[20:23], v[160:163], v[72:75]
    ds_read_b64_tr_b16 v[156:157], v15 offset:40960
    ds_read_b64_tr_b16 v[158:159], v15 offset:42240
    global_load_dwordx4 v[36:39], v4, s[46:47] offset:-2048 sc1
    global_load_dwordx4 v[104:107], v8, s[46:47] sc1
    s_waitcnt vmcnt(4)
    s_bitcmp1_b32 s14, 1
    s_cbranch_scc1 Lp_yc_84
    v_readlane_b32 s10, v108, 1
    s_nop 0
    s_cmp_eq_u32 s10, 16
    s_cbranch_scc1 Lp_yd_85
    v_mov_b32 v96, s63
    s_mov_b32 s13, 32768
    v_mov_b32 v98, 0
    s_mov_b64 exec, 1
Lpoll_86:
    global_atomic_add v97, v96, v98, s[46:47] sc0 sc1
    s_sub_u32 s13, s13, 1
    s_cselect_b32 s12, 0, -1
    s_waitcnt vmcnt(0)
    v_cmp_ne_u32_e64 vcc, 16, v97
    s_nop 0
    s_and_b32 s12, s12, vcc_lo
    s_cbranch_scc1 Lpoll_86
    s_mov_b64 exec, -1
Lp_yd_85:
    s_cmp_ge_u32 s60, 2
    s_cbranch_scc1 Lp_y2_87
    global_load_dwordx4 v[100:103], v9, s[46:47] sc1
Lp_y2_87:
    global_load_dwordx4 v[96:99], v5, s[46:47] sc1
Lp_yc_84:
    v_mfma_f32_16x16x32_bf16 v[56:59], v[24:27], v[164:167], v[56:59]
    ds_read_b64_tr_b16 v[160:161], v15 offset:40992
    ds_read_b64_tr_b16 v[162:163], v15 offset:42272
    v_mfma_f32_16x16x32_bf16 v[60:63], v[24:27], v[168:171], v[60:63]
    ds_read_b64_tr_b16 v[164:165], v15 offset:41024
    ds_read_b64_tr_b16 v[166:167], v15 offset:42304
    v_mfma_f32_16x16x32_bf16 v[64:67], v[24:27], v[172:175], v[64:67]
    ds_read_b64_tr_b16 v[168:169], v15 offset:41056
    ds_read_b64_tr_b16 v[170:171], v15 offset:42336
    v_mfma_f32_16x16x32_bf16 v[68:71], v[24:27], v[176:179], v[68:71]
    ds_read_b64_tr_b16 v[172:173], v15 offset:41088
    ds_read_b64_tr_b16 v[174:175], v15 offset:42368
    v_mfma_f32_16x16x32_bf16 v[72:75], v[24:27], v[180:183], v[72:75]
    ds_read_b64_tr_b16 v[176:177], v15 offset:46080
    ds_read_b64_tr_b16 v[178:179], v15 offset:47360
    global_load_dwordx4 v[40:43], v4, s[46:47] offset:0 sc1
    s_waitcnt vmcnt(4)
    v_mfma_f32_16x16x32_bf16 v[56:59], v[28:31], v[184:187], v[56:59]
    ds_read_b64_tr_b16 v[180:181], v15 offset:46112
    ds_read_b64_tr_b16 v[182:183], v15 offset:47392
    v_mfma_f32_16x16x32_bf16 v[60:63], v[28:31], v[188:191], v[60:63]
    ds_read_b64_tr_b16 v[184:185], v15 offset:46144
    ds_read_b64_tr_b16 v[186:187], v15 offset:47424
    v_mfma_f32_16x16x32_bf16 v[64:67], v[28:31], v[192:195], v[64:67]
    ds_read_b64_tr_b16 v[188:189], v15 offset:46176
    ds_read_b64_tr_b16 v[190:191], v15 offset:47456
    v_mfma_f32_16x16x32_bf16 v[68:71], v[28:31], v[196:199], v[68:71]
    ds_read_b64_tr_b16 v[192:193], v15 offset:46208
    ds_read_b64_tr_b16 v[194:195], v15 offset:47488
    v_mfma_f32_16x16x32_bf16 v[72:75], v[28:31], v[200:203], v[72:75]
    global_load_dwordx4 v[44:47], v4, s[46:47] offset:2048 sc1
    s_waitcnt vmcnt(4)
    s_waitcnt lgkmcnt(15)
    v_mfma_f32_16x16x32_bf16 v[56:59], v[32:35], v[204:207], v[56:59]
    v_mfma_f32_16x16x32_bf16 v[60:63], v[32:35], v[208:211], v[60:63]
    v_mfma_f32_16x16x32_bf16 v[64:67], v[32:35], v[212:215], v[64:67]
    v_mfma_f32_16x16x32_bf16 v[68:71], v[32:35], v[216:219], v[68:71]
    v_mfma_f32_16x16x32_bf16 v[72:75], v[32:35], v[220:223], v[72:75]
    global_load_dwordx4 v[48:51], v13, s[46:47] offset:-4096 sc1
    s_waitcnt vmcnt(4)
    v_mfma_f32_16x16x32_bf16 v[56:59], v[36:39], v[224:227], v[56:59]
    v_mfma_f32_16x16x32_bf16 v[60:63], v[36:39], v[228:231], v[60:63]
    v_mfma_f32_16x16x32_bf16 v[64:67], v[36:39], v[232:235], v[64:67]
    v_mfma_f32_16x16x32_bf16 v[68:71], v[36:39], v[236:239], v[68:71]
    v_mfma_f32_16x16x32_bf16 v[72:75], v[36:39], v[240:243], v[72:75]
    global_load_dwordx4 v[52:55], v13, s[46:47] offset:-2048 sc1
    s_bitcmp1_b32 s14, 1
    s_cbranch_scc1 Lp_yl_88
    s_waitcnt vmcnt(4)
Lp_yl_88:
    ds_write_b128 v2, v[96:99]
    s_cmp_lt_u32 s60, 2
    s_cselect_b64 exec, -1, 0
    ds_write_b128 v2, v[100:103] offset:8192
    s_mov_b64 exec, -1
    s_waitcnt vmcnt(3)
    v_mfma_f32_16x16x32_bf16 v[56:59], v[40:43], v[244:247], v[56:59]
    v_mfma_f32_16x16x32_bf16 v[60:63], v[40:43], v[248:251], v[60:63]
    v_mfma_f32_16x16x32_bf16 v[64:67], v[40:43], v[124:127], v[64:67]
    v_mfma_f32_16x16x32_bf16 v[68:71], v[40:43], v[128:131], v[68:71]
    v_mfma_f32_16x16x32_bf16 v[72:75], v[40:43], v[132:135], v[72:75]
    s_waitcnt lgkmcnt(0)
    s_barrier
    ds_read_b64 v[78:79], v10 offset:0
    ds_read_b64 v[82:83], v10 offset:2048
    ds_read_b64 v[86:87], v10 offset:4096
    ds_read_b64 v[90:91], v10 offset:6144
    ds_read_b64 v[94:95], v10 offset:8192
    s_waitcnt vmcnt(2)
    v_mfma_f32_16x16x32_bf16 v[56:59], v[44:47], v[136:139], v[56:59]
    v_mfma_f32_16x16x32_bf16 v[60:63], v[44:47], v[140:143], v[60:63]
    v_mfma_f32_16x16x32_bf16 v[64:67], v[44:47], v[144:147], v[64:67]
    v_mfma_f32_16x16x32_bf16 v[68:71], v[44:47], v[148:151], v[68:71]
    v_mfma_f32_16x16x32_bf16 v[72:75], v[44:47], v[152:155], v[72:75]
    s_waitcnt vmcnt(1)
    v_mfma_f32_16x16x32_bf16 v[56:59], v[48:51], v[156:159], v[56:59]
    s_waitcnt lgkmcnt(4)
    v_lshlrev_b32_e64 v76, 16, v78
    v_and_b32 v77, 0xffff0000, v78
    v_mfma_f32_16x16x32_bf16 v[60:63], v[48:51], v[160:163], v[60:63]
    v_lshlrev_b32_e64 v78, 16, v79
    v_and_b32 v79, 0xffff0000, v79
    v_mfma_f32_16x16x32_bf16 v[64:67], v[48:51], v[164:167], v[64:67]
    s_waitcnt lgkmcnt(3)
    v_lshlrev_b32 v80, 16, v82
    v_and_b32 v81, 0xffff0000, v82
    v_mfma_f32_16x16x32_bf16 v[68:71], v[48:51], v[168:171], v[68:71]
    v_lshlrev_b32_e64 v82, 16, v83
    v_and_b32 v83, 0xffff0000, v83
    v_mfma_f32_16x16x32_bf16 v[72:75], v[48:51], v[172:175], v[72:75]
    s_waitcnt lgkmcnt(2)
    v_lshlrev_b32 v84, 16, v86
    v_and_b32 v85, 0xffff0000, v86
    s_waitcnt vmcnt(0)
    v_mfma_f32_16x16x32_bf16 v[56:59], v[52:55], v[176:179], v[56:59]
    v_lshlrev_b32 v86, 16, v87
    v_and_b32 v87, 0xffff0000, v87
    v_mfma_f32_16x16x32_bf16 v[60:63], v[52:55], v[180:183], v[60:63]
    s_waitcnt lgkmcnt(1)
    v_lshlrev_b32 v88, 16, v90
    v_and_b32 v89, 0xffff0000, v90
    v_mfma_f32_16x16x32_bf16 v[64:67], v[52:55], v[184:187], v[64:67]
    v_lshlrev_b32_e64 v90, 16, v91
    v_and_b32 v91, 0xffff0000, v91
    v_mfma_f32_16x16x32_bf16 v[68:71], v[52:55], v[188:191], v[68:71]
    s_waitcnt lgkmcnt(0)
    v_lshlrev_b32 v92, 16, v94
    v_and_b32 v93, 0xffff0000, v94
    v_mfma_f32_16x16x32_bf16 v[72:75], v[52:55], v[192:195], v[72:75]
    v_lshlrev_b32_e64 v94, 16, v95
    v_and_b32 v95, 0xffff0000, v95
    s_mul_i32 s7, s61, 81920
    s_mul_i32 s8, s62, 160
    s_add_u32 s7, s7, s8
    s_lshl_b32 m0, s60, 8
    s_cmp_lg_u32 s5, 0
    s_cbranch_scc1 Lp_ny_89
    v_fmac_f32 v56, v76, v104
    v_fmac_f32 v57, v77, v105
    v_fmac_f32 v58, v78, v106
    v_fmac_f32 v59, v79, v107
    v_fmac_f32 v60, v80, v104
    v_fmac_f32 v61, v81, v105
    v_fmac_f32 v62, v82, v106
    v_fmac_f32 v63, v83, v107
    v_fmac_f32 v64, v84, v104
    v_fmac_f32 v65, v85, v105
    v_fmac_f32 v66, v86, v106
    v_fmac_f32 v67, v87, v107
    v_fmac_f32 v68, v88, v104
    v_fmac_f32 v69, v89, v105
    v_fmac_f32 v70, v90, v106
    v_fmac_f32 v71, v91, v107
    v_fmac_f32 v72, v92, v104
    v_fmac_f32 v73, v93, v105
    v_fmac_f32 v74, v94, v106
    v_fmac_f32 v75, v95, v107
Lp_ny_89:
    ds_write_addtid_b32 v56 offset:0
    ds_write_addtid_b32 v57 offset:2176
    ds_write_addtid_b32 v58 offset:4352
    ds_write_addtid_b32 v59 offset:6528
    ds_write_addtid_b32 v60 offset:8720
    ds_write_addtid_b32 v61 offset:10896
    ds_write_addtid_b32 v62 offset:13072
    ds_write_addtid_b32 v63 offset:15248
    ds_write_addtid_b32 v64 offset:17472
    ds_write_addtid_b32 v65 offset:19648
    ds_write_addtid_b32 v66 offset:21824
    ds_write_addtid_b32 v67 offset:24000
    ds_write_addtid_b32 v68 offset:26192
    ds_write_addtid_b32 v69 offset:28368
    ds_write_addtid_b32 v70 offset:30544
    ds_write_addtid_b32 v71 offset:32720
    ds_write_addtid_b32 v72 offset:34944
    ds_write_addtid_b32 v73 offset:37120
    ds_write_addtid_b32 v74 offset:39296
    ds_write_addtid_b32 v75 offset:41472
    s_waitcnt lgkmcnt(0)
    s_barrier
    ds_read_b128 v[16:19], v113 offset:0
    ds_read_b128 v[20:23], v113 offset:16
    ds_read_b128 v[24:27], v113 offset:1024
    ds_read_b128 v[28:31], v113 offset:1040
    s_mov_b32 exec_hi, 0
    ds_read_b128 v[32:35], v115 offset:34944
    ds_read_b128 v[36:39], v115 offset:35968
    s_mov_b32 exec_hi, -1
    s_waitcnt lgkmcnt(3)
    v_pk_add_f32 v[16:17], v[16:17], v[24:25]
    v_pk_add_f32 v[18:19], v[18:19], v[26:27]
    s_waitcnt lgkmcnt(2)
    v_pk_add_f32 v[20:21], v[20:21], v[28:29]
    v_pk_add_f32 v[22:23], v[22:23], v[30:31]
    v_cvt_pk_bf16_f32 v16, v16, v17
    v_cvt_pk_bf16_f32 v17, v18, v19
    v_cvt_pk_bf16_f32 v18, v20, v21
    v_cvt_pk_bf16_f32 v19, v22, v23
    buffer_store_dwordx4 v[16:19], v112, s[48:51], s7 offen
    s_waitcnt lgkmcnt(0)
    v_pk_add_f32 v[32:33], v[32:33], v[36:37]
    v_pk_add_f32 v[34:35], v[34:35], v[38:39]
    v_cvt_pk_bf16_f32 v32, v32, v33
    v_cvt_pk_bf16_f32 v33, v34, v35
    s_mov_b32 exec_hi, 0
    buffer_store_dwordx2 v[32:33], v114, s[48:51], s7 offen
    s_mov_b64 exec, -1
L_end:
    s_endpgm
.p2align 8
L_tab_band:
    .long 0x0, 0x0, 0x0, 0x3f803f80, 0x0, 0x0, 0x0, 0x3f800000
    .long 0x0, 0x0, 0x0, 0x0, 0x0, 0x0, 0x0, 0x0
    .long 0x0, 0x0, 0x0, 0x0, 0x0, 0x0, 0x0, 0x0
    .long 0x0, 0x0, 0x0, 0x0, 0x0, 0x0, 0x0, 0x0
    .long 0x0, 0x0, 0x0, 0x0, 0x0, 0x0, 0x0, 0x0
    .long 0x0, 0x0, 0x0, 0x0, 0x0, 0x0, 0x0, 0x0
    .long 0x0, 0x0, 0x0, 0x0, 0x0, 0x0, 0x0, 0x0
    .long 0x0, 0x0, 0x0, 0x0, 0x0, 0x0, 0x0, 0x0
    .long 0x3f803f80, 0x3f80, 0x0, 0x0, 0x3f803f80, 0x3f803f80, 0x0, 0x0
    .long 0x3f803f80, 0x3f803f80, 0x3f80, 0x0, 0x3f800000, 0x3f803f80, 0x3f803f80, 0x0
    .long 0x0, 0x3f803f80, 0x3f803f80, 0x3f80, 0x0, 0x3f800000, 0x3f803f80, 0x3f803f80
    .long 0x0, 0x0, 0x3f803f80, 0x3f803f80, 0x0, 0x0, 0x3f800000, 0x3f803f80
    .long 0x0, 0x0, 0x0, 0x3f803f80, 0x0, 0x0, 0x0, 0x3f800000
    .long 0x0, 0x0, 0x0, 0x0, 0x0, 0x0, 0x0, 0x0
    .long 0x0, 0x0, 0x0, 0x0, 0x0, 0x0, 0x0, 0x0
    .long 0x0, 0x0, 0x0, 0x0, 0x0, 0x0, 0x0, 0x0
    .long 0x0, 0x0, 0x0, 0x0, 0x0, 0x0, 0x0, 0x0
    .long 0x0, 0x0, 0x0, 0x0, 0x0, 0x0, 0x0, 0x0
    .long 0x0, 0x0, 0x0, 0x0, 0x0, 0x0, 0x0, 0x0
    .long 0x3f80, 0x0, 0x0, 0x0, 0x3f803f80, 0x0, 0x0, 0x0
    .long 0x3f803f80, 0x3f80, 0x0, 0x0, 0x3f803f80, 0x3f803f80, 0x0, 0x0
    .long 0x3f803f80, 0x3f803f80, 0x3f80, 0x0, 0x3f800000, 0x3f803f80, 0x3f803f80, 0x0
    .long 0x0, 0x3f803f80, 0x3f803f80, 0x3f80, 0x0, 0x3f800000, 0x3f803f80, 0x3f803f80
    .long 0x0, 0x0, 0x3f803f80, 0x3f803f80, 0x0, 0x0, 0x3f800000, 0x3f803f80
    .long 0x0, 0x0, 0x0, 0x0, 0x0, 0x0, 0x0, 0x0
    .long 0x0, 0x0, 0x0, 0x0, 0x0, 0x0, 0x0, 0x0
    .long 0x0, 0x0, 0x0, 0x0, 0x0, 0x0, 0x0, 0x0
    .long 0x0, 0x0, 0x0, 0x0, 0x0, 0x0, 0x0, 0x0
    .long 0x0, 0x0, 0x0, 0x0, 0x0, 0x0, 0x0, 0x0
    .long 0x0, 0x0, 0x0, 0x0, 0x0, 0x0, 0x0, 0x0
    .long 0x0, 0x0, 0x0, 0x0, 0x0, 0x0, 0x0, 0x0
    .long 0x3f80, 0x0, 0x0, 0x0, 0x3f803f80, 0x0, 0x0, 0x0
    .long 0x0, 0x0, 0x0, 0x0, 0x0, 0x0, 0x0, 0x0
    .long 0x0, 0x0, 0x0, 0x0, 0x0, 0x0, 0x0, 0x0
    .long 0x0, 0x0, 0x0, 0x0, 0x0, 0x0, 0x0, 0x0
    .long 0x0, 0x0, 0x0, 0x0, 0x0, 0x0, 0x0, 0x0
    .long 0x0, 0x0, 0x0, 0x0, 0x0, 0x0, 0x0, 0x0
    .long 0x0, 0x0, 0x0, 0x0, 0x0, 0x0, 0x0, 0x0
    .long 0x0, 0x0, 0x0, 0x0, 0x0, 0x0, 0x0, 0x0
    .long 0x0, 0x0, 0x0, 0x0, 0x0, 0x0, 0x0, 0x0
    .long 0x0, 0x3f800000, 0x3f803f80, 0x0, 0x0, 0x0, 0x3f803f80, 0x3f80
    .long 0x0, 0x0, 0x3f800000, 0x3f803f80, 0x0, 0x0, 0x0, 0x3f803f80
    .long 0x0, 0x0, 0x0, 0x3f800000, 0x0, 0x0, 0x0, 0x0
    .long 0x0, 0x0, 0x0, 0x0, 0x0, 0x0, 0x0, 0x0
    .long 0x0, 0x0, 0x0, 0x0, 0x0, 0x0, 0x0, 0x0
    .long 0x0, 0x0, 0x0, 0x0, 0x0, 0x0, 0x0, 0x0
    .long 0x0, 0x0, 0x0, 0x0, 0x0, 0x0, 0x0, 0x0
    .long 0x0, 0x0, 0x0, 0x0, 0x0, 0x0, 0x0, 0x0
    .long 0x0, 0x0, 0x0, 0x0, 0x0, 0x0, 0x0, 0x0
    .long 0x0, 0x0, 0x0, 0x0, 0x3f80, 0x0, 0x0, 0x0
    .long 0x3f803f80, 0x0, 0x0, 0x0, 0x3f803f80, 0x3f80, 0x0, 0x0
    .long 0x3f800000, 0x3f803f80, 0x0, 0x0, 0x0, 0x3f803f80, 0x3f80, 0x0
    .long 0x0, 0x3f800000, 0x3f803f80, 0x0, 0x0, 0x0, 0x3f803f80, 0x3f80
    .long 0x0, 0x0, 0x3f800000, 0x3f803f80, 0x0, 0x0, 0x0, 0x3f803f80
    .long 0x0, 0x0, 0x0, 0x3f800000, 0x0, 0x0, 0x0, 0x0
    .long 0x0, 0x0, 0x0, 0x0, 0x0, 0x0, 0x0, 0x0
    .long 0x0, 0x0, 0x0, 0x0, 0x0, 0x0, 0x0, 0x0
    .long 0x0, 0x0, 0x0, 0x0, 0x0, 0x0, 0x0, 0x0
    .long 0x0, 0x0, 0x0, 0x0, 0x0, 0x0, 0x0, 0x0
    .long 0x0, 0x0, 0x0, 0x0, 0x0, 0x0, 0x0, 0x0
    .long 0x0, 0x0, 0x0, 0x0, 0x0, 0x0, 0x0, 0x0
    .long 0x0, 0x0, 0x0, 0x0, 0x3f80, 0x0, 0x0, 0x0
    .long 0x3f803f80, 0x0, 0x0, 0x0, 0x3f803f80, 0x3f80, 0x0, 0x0
    .long 0x3f800000, 0x3f803f80, 0x0, 0x0, 0x0, 0x3f803f80, 0x3f80, 0x0
    .long 0x0, 0x0, 0x0, 0x3f803f80, 0x0, 0x0, 0x0, 0x3f800000
    .long 0x0, 0x0, 0x0, 0x0, 0x0, 0x0, 0x0, 0x0
    .long 0x0, 0x0, 0x0, 0x0, 0x0, 0x0, 0x0, 0x0
    .long 0x0, 0x0, 0x0, 0x0, 0x0, 0x0, 0x0, 0x0
    .long 0x0, 0x0, 0x0, 0x0, 0x0, 0x0, 0x0, 0x0
    .long 0x0, 0x0, 0x0, 0x0, 0x0, 0x0, 0x0, 0x0
    .long 0x0, 0x0, 0x0, 0x0, 0x0, 0x0, 0x0, 0x0
    .long 0x0, 0x0, 0x0, 0x0, 0x0, 0x0, 0x0, 0x0
    .long 0x3f803f80, 0x3f80, 0x0, 0x0, 0x3f803f80, 0x3f803f80, 0x0, 0x0
    .long 0x3f803f80, 0x3f803f80, 0x3f80, 0x0, 0x3f800000, 0x3f803f80, 0x3f803f80, 0x0
    .long 0x0, 0x3f803f80, 0x3f803f80, 0x3f80, 0x0, 0x3f800000, 0x3f803f80, 0x3f803f80
    .long 0x0, 0x0, 0x3f803f80, 0x3f803f80, 0x0, 0x0, 0x3f800000, 0x3f803f80
    .long 0x0, 0x0, 0x0, 0x3f803f80, 0x0, 0x0, 0x0, 0x3f800000
    .long 0x0, 0x0, 0x0, 0x0, 0x0, 0x0, 0x0, 0x0
    .long 0x0, 0x0, 0x0, 0x0, 0x0, 0x0, 0x0, 0x0
    .long 0x0, 0x0, 0x0, 0x0, 0x0, 0x0, 0x0, 0x0
    .long 0x0, 0x0, 0x0, 0x0, 0x0, 0x0, 0x0, 0x0
    .long 0x0, 0x0, 0x0, 0x0, 0x0, 0x0, 0x0, 0x0
    .long 0x0, 0x0, 0x0, 0x0, 0x0, 0x0, 0x0, 0x0
    .long 0x3f80, 0x0, 0x0, 0x0, 0x3f803f80, 0x0, 0x0, 0x0
    .long 0x3f803f80, 0x3f80, 0x0, 0x0, 0x3f803f80, 0x3f803f80, 0x0, 0x0
    .long 0x3f803f80, 0x3f803f80, 0x3f80, 0x0, 0x3f800000, 0x3f803f80, 0x3f803f80, 0x0
    .long 0x0, 0x3f803f80, 0x3f803f80, 0x3f80, 0x0, 0x3f800000, 0x3f803f80, 0x3f803f80
    .long 0x0, 0x0, 0x3f803f80, 0x3f803f80, 0x0, 0x0, 0x3f800000, 0x3f803f80
    .long 0x0, 0x0, 0x0, 0x0, 0x0, 0x0, 0x0, 0x0
    .long 0x0, 0x0, 0x0, 0x0, 0x0, 0x0, 0x0, 0x0
    .long 0x0, 0x0, 0x0, 0x0, 0x0, 0x0, 0x0, 0x0
    .long 0x0, 0x0, 0x0, 0x0, 0x0, 0x0, 0x0, 0x0
    .long 0x0, 0x0, 0x0, 0x0, 0x0, 0x0, 0x0, 0x0
    .long 0x0, 0x0, 0x0, 0x0, 0x0, 0x0, 0x0, 0x0
    .long 0x0, 0x0, 0x0, 0x0, 0x0, 0x0, 0x0, 0x0
    .long 0x3f80, 0x0, 0x0, 0x0, 0x3f803f80, 0x0, 0x0, 0x0
    .long 0x0, 0x3f800000, 0x3f803f80, 0x0, 0x0, 0x0, 0x3f803f80, 0x3f80
    .long 0x0, 0x0, 0x3f800000, 0x3f803f80, 0x0, 0x0, 0x0, 0x3f803f80
    .long 0x0, 0x0, 0x0, 0x3f800000, 0x0, 0x0, 0x0, 0x0
    .long 0x0, 0x0, 0x0, 0x0, 0x0, 0x0, 0x0, 0x0
    .long 0x0, 0x0, 0x0, 0x0, 0x0, 0x0, 0x0, 0x0
    .long 0x0, 0x0, 0x0, 0x0, 0x0, 0x0, 0x0, 0x0
    .long 0x0, 0x0, 0x0, 0x0, 0x0, 0x0, 0x0, 0x0
    .long 0x0, 0x0, 0x0, 0x0, 0x0, 0x0, 0x0, 0x0
    .long 0x0, 0x0, 0x0, 0x0, 0x0, 0x0, 0x0, 0x0
    .long 0x0, 0x0, 0x0, 0x0, 0x3f80, 0x0, 0x0, 0x0
    .long 0x3f803f80, 0x0, 0x0, 0x0, 0x3f803f80, 0x3f80, 0x0, 0x0
    .long 0x3f800000, 0x3f803f80, 0x0, 0x0, 0x0, 0x3f803f80, 0x3f80, 0x0
    .long 0x0, 0x3f800000, 0x3f803f80, 0x0, 0x0, 0x0, 0x3f803f80, 0x3f80
    .long 0x0, 0x0, 0x3f800000, 0x3f803f80, 0x0, 0x0, 0x0, 0x3f803f80
    .long 0x0, 0x0, 0x0, 0x3f800000, 0x0, 0x0, 0x0, 0x0
    .long 0x0, 0x0, 0x0, 0x0, 0x0, 0x0, 0x0, 0x0
    .long 0x0, 0x0, 0x0, 0x0, 0x0, 0x0, 0x0, 0x0
    .long 0x0, 0x0, 0x0, 0x0, 0x0, 0x0, 0x0, 0x0
    .long 0x0, 0x0, 0x0, 0x0, 0x0, 0x0, 0x0, 0x0
    .long 0x0, 0x0, 0x0, 0x0, 0x0, 0x0, 0x0, 0x0
    .long 0x0, 0x0, 0x0, 0x0, 0x0, 0x0, 0x0, 0x0
    .long 0x0, 0x0, 0x0, 0x0, 0x3f80, 0x0, 0x0, 0x0
    .long 0x3f803f80, 0x0, 0x0, 0x0, 0x3f803f80, 0x3f80, 0x0, 0x0
    .long 0x3f800000, 0x3f803f80, 0x0, 0x0, 0x0, 0x3f803f80, 0x3f80, 0x0
    .long 0x0, 0x0, 0x0, 0x0, 0x0, 0x0, 0x0, 0x0
    .long 0x0, 0x0, 0x0, 0x0, 0x0, 0x0, 0x0, 0x0
    .long 0x0, 0x0, 0x0, 0x0, 0x0, 0x0, 0x0, 0x0
    .long 0x0, 0x0, 0x0, 0x0, 0x0, 0x0, 0x0, 0x0
    .long 0x0, 0x0, 0x0, 0x0, 0x0, 0x0, 0x0, 0x0
    .long 0x0, 0x0, 0x0, 0x0, 0x0, 0x0, 0x0, 0x0
    .long 0x0, 0x0, 0x0, 0x0, 0x0, 0x0, 0x0, 0x0
    .long 0x0, 0x0, 0x0, 0x0, 0x0, 0x0, 0x0, 0x0
    .long 0x0, 0x0, 0x3f803f80, 0x3f803f80, 0x0, 0x0, 0x3f800000, 0x3f803f80
    .long 0x0, 0x0, 0x0, 0x3f803f80, 0x0, 0x0, 0x0, 0x3f800000
    .long 0x0, 0x0, 0x0, 0x0, 0x0, 0x0, 0x0, 0x0
    .long 0x0, 0x0, 0x0, 0x0, 0x0, 0x0, 0x0, 0x0
    .long 0x0, 0x0, 0x0, 0x0, 0x0, 0x0, 0x0, 0x0
    .long 0x0, 0x0, 0x0, 0x0, 0x0, 0x0, 0x0, 0x0
    .long 0x0, 0x0, 0x0, 0x0, 0x0, 0x0, 0x0, 0x0
    .long 0x0, 0x0, 0x0, 0x0, 0x0, 0x0, 0x0, 0x0
    .long 0x3f803f80, 0x3f803f80, 0x3f80, 0x0, 0x3f803f80, 0x3f803f80, 0x3f803f80, 0x0
    .long 0x3f803f80, 0x3f803f80, 0x3f803f80, 0x3f80, 0x3f803f80, 0x3f803f80, 0x3f803f80, 0x3f803f80
    .long 0x3f803f80, 0x3f803f80, 0x3f803f80, 0x3f803f80, 0x3f800000, 0x3f803f80, 0x3f803f80, 0x3f803f80
    .long 0x0, 0x3f803f80, 0x3f803f80, 0x3f803f80, 0x0, 0x3f800000, 0x3f803f80, 0x3f803f80
    .long 0x0, 0x0, 0x3f803f80, 0x3f803f80, 0x0, 0x0, 0x3f800000, 0x3f803f80
    .long 0x0, 0x0, 0x0, 0x3f803f80, 0x0, 0x0, 0x0, 0x3f800000
    .long 0x0, 0x0, 0x0, 0x0, 0x0, 0x0, 0x0, 0x0
    .long 0x0, 0x0, 0x0, 0x0, 0x0, 0x0, 0x0, 0x0
    .long 0x0, 0x0, 0x0, 0x0, 0x0, 0x0, 0x0, 0x0
    .long 0x0, 0x0, 0x0, 0x0, 0x0, 0x0, 0x0, 0x0
    .long 0x3f80, 0x0, 0x0, 0x0, 0x3f803f80, 0x0, 0x0, 0x0
    .long 0x3f803f80, 0x3f80, 0x0, 0x0, 0x3f803f80, 0x3f803f80, 0x0, 0x0
    .long 0x3f803f80, 0x3f803f80, 0x3f80, 0x0, 0x3f803f80, 0x3f803f80, 0x3f803f80, 0x0
    .long 0x3f803f80, 0x3f803f80, 0x3f803f80, 0x3f80, 0x3f803f80, 0x3f803f80, 0x3f803f80, 0x3f803f80
    .long 0x3f803f80, 0x3f803f80, 0x3f803f80, 0x3f803f80, 0x3f800000, 0x3f803f80, 0x3f803f80, 0x3f803f80
    .long 0x0, 0x3f803f80, 0x3f803f80, 0x3f803f80, 0x0, 0x3f800000, 0x3f803f80, 0x3f803f80
    .long 0x0, 0x0, 0x0, 0x0, 0x0, 0x0, 0x0, 0x0
    .long 0x0, 0x0, 0x0, 0x0, 0x0, 0x0, 0x0, 0x0
    .long 0x0, 0x0, 0x0, 0x0, 0x0, 0x0, 0x0, 0x0
    .long 0x0, 0x0, 0x0, 0x0, 0x0, 0x0, 0x0, 0x0
    .long 0x0, 0x0, 0x0, 0x0, 0x0, 0x0, 0x0, 0x0
    .long 0x0, 0x0, 0x0, 0x0, 0x0, 0x0, 0x0, 0x0
    .long 0x3f80, 0x0, 0x0, 0x0, 0x3f803f80, 0x0, 0x0, 0x0
    .long 0x3f803f80, 0x3f80, 0x0, 0x0, 0x3f803f80, 0x3f803f80, 0x0, 0x0
    .long 0x0, 0x0, 0x3f800000, 0x3f803f80, 0x0, 0x0, 0x0, 0x3f803f80
    .long 0x0, 0x0, 0x0, 0x3f800000, 0x0, 0x0, 0x0, 0x0
    .long 0x0, 0x0, 0x0, 0x0, 0x0, 0x0, 0x0, 0x0
    .long 0x0, 0x0, 0x0, 0x0, 0x0, 0x0, 0x0, 0x0
    .long 0x0, 0x0, 0x0, 0x0, 0x0, 0x0, 0x0, 0x0
    .long 0x0, 0x0, 0x0, 0x0, 0x0, 0x0, 0x0, 0x0
    .long 0x0, 0x0, 0x0, 0x0, 0x0, 0x0, 0x0, 0x0
    .long 0x0, 0x0, 0x0, 0x0, 0x0, 0x0, 0x0, 0x0
    .long 0x3f803f80, 0x3f803f80, 0x0, 0x0, 0x3f803f80, 0x3f803f80, 0x3f80, 0x0
    .long 0x3f803f80, 0x3f803f80, 0x3f803f80, 0x0, 0x3f803f80, 0x3f803f80, 0x3f803f80, 0x3f80
    .long 0x3f800000, 0x3f803f80, 0x3f803f80, 0x3f803f80, 0x0, 0x3f803f80, 0x3f803f80, 0x3f803f80
    .long 0x0, 0x3f800000, 0x3f803f80, 0x3f803f80, 0x0, 0x0, 0x3f803f80, 0x3f803f80
    .long 0x0, 0x0, 0x3f800000, 0x3f803f80, 0x0, 0x0, 0x0, 0x3f803f80
    .long 0x0, 0x0, 0x0, 0x3f800000, 0x0, 0x0, 0x0, 0x0
    .long 0x0, 0x0, 0x0, 0x0, 0x0, 0x0, 0x0, 0x0
    .long 0x0, 0x0, 0x0, 0x0, 0x0, 0x0, 0x0, 0x0
    .long 0x0, 0x0, 0x0, 0x0, 0x0, 0x0, 0x0, 0x0
    .long 0x0, 0x0, 0x0, 0x0, 0x0, 0x0, 0x0, 0x0
    .long 0x0, 0x0, 0x0, 0x0, 0x3f80, 0x0, 0x0, 0x0
    .long 0x3f803f80, 0x0, 0x0, 0x0, 0x3f803f80, 0x3f80, 0x0, 0x0
    .long 0x3f803f80, 0x3f803f80, 0x0, 0x0, 0x3f803f80, 0x3f803f80, 0x3f80, 0x0
    .long 0x3f803f80, 0x3f803f80, 0x3f803f80, 0x0, 0x3f803f80, 0x3f803f80, 0x3f803f80, 0x3f80
    .long 0x3f800000, 0x3f803f80, 0x3f803f80, 0x3f803f80, 0x0, 0x3f803f80, 0x3f803f80, 0x3f803f80
    .long 0x0, 0x3f800000, 0x3f803f80, 0x3f803f80, 0x0, 0x0, 0x3f803f80, 0x3f803f80
    .long 0x0, 0x0, 0x0, 0x0, 0x0, 0x0, 0x0, 0x0
    .long 0x0, 0x0, 0x0, 0x0, 0x0, 0x0, 0x0, 0x0
    .long 0x0, 0x0, 0x0, 0x0, 0x0, 0x0, 0x0, 0x0
    .long 0x0, 0x0, 0x0, 0x0, 0x0, 0x0, 0x0, 0x0
    .long 0x0, 0x0, 0x0, 0x0, 0x0, 0x0, 0x0, 0x0
    .long 0x0, 0x0, 0x0, 0x0, 0x0, 0x0, 0x0, 0x0
    .long 0x0, 0x0, 0x0, 0x0, 0x3f80, 0x0, 0x0, 0x0
    .long 0x3f803f80, 0x0, 0x0, 0x0, 0x3f803f80, 0x3f80, 0x0, 0x0
L_tab_src:
    .short 3068, 3068, 3068, 3068, 3068, 3068, 3068, 3068, 3068, 3068, 3068, 3068, 3068, 3068, 3068, 3068
    .short 3068, 3068, 3068, 3068, 3068, 3068, 3068, 3068, 3068, 3068, 3068, 3068, 3068, 132, 132, 132
    .short 132, 3016, 808, 808, 808, 1912, 1636, 1636, 1636, 3012, 804, 804, 804, 1908, 1632, 1632
    .short 1632, 3008, 800, 800, 800, 1904, 1628, 1628, 1628, 3004, 796, 796, 796, 1900, 1624, 1624
    .short 1624, 3000, 792, 792, 792, 1896, 1620, 1620, 1620, 2996, 788, 788, 788, 1892, 1616, 1616
    .short 1616, 2992, 784, 784, 784, 1888, 1612, 1612, 1612, 2988, 780, 780, 780, 1884, 1608, 1608
    .short 1608, 2984, 776, 776, 776, 1880, 1604, 1604, 1604, 2980, 772, 772, 772, 1876, 1600, 1600
    .short 1600, 2976, 768, 768, 768, 1872, 1596, 1596, 1596, 2972, 764, 764, 764, 1868, 1592, 1592
    .short 1592, 2968, 760, 760, 760, 1864, 1588, 1588, 1588, 2964, 756, 756, 756, 1860, 1584, 1584
    .short 1584, 2960, 752, 752, 752, 1856, 1580, 1580, 1580, 2956, 748, 748, 748, 1852, 1576, 1576
    .short 1576, 2952, 744, 744, 744, 1848, 1572, 1572, 1572, 2948, 740, 740, 740, 1844, 1568, 1568
    .short 1568, 2944, 736, 736, 736, 1840, 1564, 1564, 1564, 2940, 732, 732, 732, 1836, 1560, 1560
    .short 1560, 2936, 728, 728, 728, 1832, 1556, 1556, 1556, 2932, 724, 724, 724, 1828, 1552, 1552
    .short 1552, 2928, 720, 720, 720, 1824, 1548, 1548, 1548, 2924, 716, 716, 716, 1820, 1544, 1544
    .short 1544, 2920, 712, 712, 712, 1816, 1540, 1540, 1540, 2916, 708, 708, 708, 1812, 1536, 1536
    .short 1536, 2912, 704, 704, 704, 1808, 1532, 1532, 1532, 2908, 700, 700, 700, 1804, 1528, 1528
    .short 1528, 2904, 696, 696, 696, 1800, 1524, 1524, 1524, 2900, 692, 692, 692, 1796, 1520, 1520
    .short 1520, 2896, 688, 688, 688, 1792, 1516, 1516, 1516, 2892, 684, 684, 684, 1788, 1512, 1512
    .short 1228, 400, 1504, 124, 2056, 1084, 676, 2464, 1224, 396, 1500, 120, 2052, 1080, 672, 2460
    .short 1220, 392, 1496, 116, 2048, 1076, 668, 2456, 1216, 388, 1492, 112, 2044, 1072, 664, 2452
    .short 1212, 384, 1488, 108, 2040, 1068, 660, 2448, 1208, 380, 1484, 104, 2036, 1064, 656, 2444
    .short 1204, 376, 1480, 100, 2032, 1060, 652, 2440, 1200, 372, 1476, 96, 2028, 1056, 648, 2436
    .short 1196, 368, 1472, 92, 2024, 1052, 644, 2432, 1192, 364, 1468, 88, 2020, 1048, 640, 2428
    .short 1188, 360, 1464, 84, 2016, 1044, 636, 2424, 1184, 356, 1460, 80, 2012, 1040, 632, 2420
    .short 1180, 352, 1456, 76, 2008, 1036, 628, 2416, 1176, 348, 1452, 72, 2004, 1032, 624, 2412
    .short 1172, 344, 1448, 68, 2000, 1028, 620, 2408, 1168, 340, 1444, 64, 1996, 1024, 616, 2404
    .short 1164, 336, 1440, 60, 1992, 1020, 612, 2400, 1160, 332, 1436, 56, 1988, 1016, 608, 2396
    .short 1156, 328, 1432, 52, 1984, 1012, 604, 2392, 1152, 324, 1428, 48, 1980, 1008, 600, 2388
    .short 1148, 320, 1424, 44, 1976, 1004, 596, 2384, 1144, 316, 1420, 40, 1972, 1000, 592, 2380
    .short 1140, 312, 1416, 36, 1968, 996, 588, 2376, 1136, 308, 1412, 32, 1964, 992, 584, 2372
    .short 1132, 304, 1408, 28, 1960, 988, 580, 2368, 1128, 300, 1404, 24, 1956, 984, 576, 2364
    .short 1124, 296, 1400, 20, 1952, 980, 572, 2360, 1120, 292, 1396, 16, 1948, 976, 568, 2356
    .short 1116, 288, 1392, 12, 1944, 972, 564, 2352, 1112, 284, 1388, 8, 1940, 968, 560, 2348
    .short 1108, 280, 1384, 4, 1936, 964, 556, 2344, 1104, 276, 1380, 0, 1932, 960, 552, 2340
    .short 3068, 3068, 3068, 3068, 3068, 3068, 3068, 3068, 3068, 3068, 3068, 3068, 3068, 3068, 3068, 3068
    .short 3068, 3068, 3068, 3068, 3068, 3068, 3068, 3068, 3068, 3068, 3068, 3068, 3068, 3068, 3068, 3068
    .short 3068, 3068, 3068, 3068, 3068, 3068, 3068, 3068, 3068, 3068, 3068, 828, 828, 3068, 3068, 3068
    .short 3068, 3068, 3068, 3068, 3068, 3068, 3068, 3068, 3068, 3068, 3068, 3068, 3068, 3068, 3068, 3068
    .short 3068, 3068, 3068, 3068, 3068, 3068, 3068, 3068, 3068, 3068, 3068, 3068, 3068, 3068, 3068, 3068
    .short 828, 2736, 2728, 2720, 2712, 2704, 2696, 2688, 2680, 2672, 2664, 2656, 2648, 2640, 2632, 2624
    .short 2616, 252, 244, 236, 228, 220, 212, 204, 196, 188, 180, 172, 164, 156, 148, 140
    .short 3068, 3068, 3068, 3068, 3068, 3068, 3068, 3068, 3068, 3068, 3068, 3068, 3068, 3068, 3068, 3068
    .short 3068, 3068, 3068, 3068, 3068, 3068, 3068, 3068, 3068, 3068, 3068, 3068, 3068, 3068, 3068, 3068
    .short 1776, 1768, 1760, 1752, 1744, 1736, 1728, 1720, 1712, 1704, 1696, 1688, 1680, 1672, 1664, 1656
    .short 2184, 2176, 2168, 2160, 2152, 2144, 2136, 2128, 2120, 2112, 2104, 2096, 2088, 2080, 2072, 2064
    .short 3068, 3068, 3068, 3068, 3068, 3068, 3068, 3068, 3068, 3068, 3068, 3068, 3068, 3068, 3068, 3068
    .short 3068, 3068, 3068, 3068, 3068, 3068, 3068, 3068, 3068, 3068, 3068, 3068, 3068, 3068, 3068, 3068
    .short 2740, 2732, 2724, 2716, 2708, 2700, 2692, 2684, 2676, 2668, 2660, 2652, 2644, 2636, 2628, 2620
    .short 256, 248, 240, 232, 224, 216, 208, 200, 192, 184, 176, 168, 160, 152, 144, 136
    .short 3068, 3068, 3068, 3068, 3068, 3068, 3068, 3068, 3068, 3068, 3068, 3068, 3068, 3068, 3068, 3068
    .short 3068, 3068, 3068, 3068, 3068, 3068, 3068, 3068, 3068, 3068, 3068, 3068, 3068, 3068, 3068, 3068
    .short 1780, 1772, 1764, 1756, 1748, 1740, 1732, 1724, 1716, 1708, 1700, 1692, 1684, 1676, 1668, 1660
    .short 2188, 2180, 2172, 2164, 2156, 2148, 2140, 2132, 2124, 2116, 2108, 2100, 2092, 2084, 2076, 2068
    .short 3068, 3068, 3068, 3068, 3068, 3068, 3068, 3068, 3068, 3068, 3068, 3068, 3068, 3068, 3068, 3068
    .short 2208, 528, 520, 512, 504, 496, 488, 480, 472, 464, 456, 448, 440, 432, 424, 416
    .short 408, 2604, 2596, 2588, 2580, 2572, 2564, 2556, 2548, 2540, 2532, 2524, 2516, 2508, 2500, 2492
    .short 2484, 2880, 2872, 2864, 2856, 2848, 2840, 2832, 2824, 2816, 2808, 2800, 2792, 2784, 2776, 2768
    .short 2760, 948, 940, 932, 924, 916, 908, 900, 892, 884, 876, 868, 860, 852, 844, 836
    .short 3068, 3068, 3068, 3068, 3068, 3068, 3068, 3068, 3068, 3068, 3068, 3068, 3068, 3068, 3068, 3068
    .short 532, 524, 516, 508, 500, 492, 484, 476, 468, 460, 452, 444, 436, 428, 420, 412
    .short 2608, 2600, 2592, 2584, 2576, 2568, 2560, 2552, 2544, 2536, 2528, 2520, 2512, 2504, 2496, 2488
    .short 2884, 2876, 2868, 2860, 2852, 2844, 2836, 2828, 2820, 2812, 2804, 2796, 2788, 2780, 2772, 2764
    .short 952, 944, 936, 928, 920, 912, 904, 896, 888, 880, 872, 864, 856, 848, 840, 832
    .short 3068, 3068, 3068, 3068, 3068, 3068, 3068, 3068, 3068, 3068, 3068, 3068, 3068, 3068, 3068, 3068
    .short 3068, 3068
L_tab_kv:
    .short 128, 132, 136, 140, 144, 148, 152, 156, 160, 164, 168, 172, 176, 180, 184, 188
    .short 8448, 8452, 8456, 8460, 1168, 1172, 1176, 1180, 1184, 1188, 1192, 1196, 1200, 1204, 1208, 1212
    .short 1216, 1220, 1224, 1228, 9488, 9492, 9496, 9500, 2208, 2212, 2216, 2220, 2224, 2228, 2232, 2236
    .short 2240, 2244, 2248, 2252, 2256, 2260, 2264, 2268, 10528, 10532, 10536, 10540, 3248, 3252, 3256, 3260
    .short 3264, 3268, 3272, 3276, 3280, 3284, 3288, 3292, 3296, 3300, 3304, 3308, 11568, 11572, 11576, 11580
    .short 192, 196, 200, 204, 208, 212, 216, 220, 224, 228, 232, 236, 240, 244, 248, 252
    .short 8512, 8516, 8520, 8524, 1232, 1236, 1240, 1244, 1248, 1252, 1256, 1260, 1264, 1268, 1272, 1276
    .short 1280, 1284, 1288, 1292, 9552, 9556, 9560, 9564, 2272, 2276, 2280, 2284, 2288, 2292, 2296, 2300
    .short 2304, 2308, 2312, 2316, 2320, 2324, 2328, 2332, 10592, 10596, 10600, 10604, 3312, 3316, 3320, 3324
    .short 3328, 3332, 3336, 3340, 3344, 3348, 3352, 3356, 3360, 3364, 3368, 3372, 11632, 11636, 11640, 11644
    .short 4160, 4164, 4168, 4172, 4176, 4180, 4184, 4188, 4192, 4196, 4200, 4204, 4208, 4212, 4216, 4220
    .short 12480, 12484, 12488, 12492, 5200, 5204, 5208, 5212, 5216, 5220, 5224, 5228, 5232, 5236, 5240, 5244
    .short 5248, 5252, 5256, 5260, 13520, 13524, 13528, 13532, 6240, 6244, 6248, 6252, 6256, 6260, 6264, 6268
    .short 6272, 6276, 6280, 6284, 6288, 6292, 6296, 6300, 14560, 14564, 14568, 14572, 7280, 7284, 7288, 7292
    .short 7296, 7300, 7304, 7308, 7312, 7316, 7320, 7324, 7328, 7332, 7336, 7340, 15600, 15604, 15608, 15612
    .short 4224, 4228, 4232, 4236, 4240, 4244, 4248, 4252, 4256, 4260, 4264, 4268, 4272, 4276, 4280, 4284
    .short 12544, 12548, 12552, 12556, 5264, 5268, 5272, 5276, 5280, 5284, 5288, 5292, 5296, 5300, 5304, 5308
    .short 5312, 5316, 5320, 5324, 13584, 13588, 13592, 13596, 6304, 6308, 6312, 6316, 6320, 6324, 6328, 6332
    .short 6336, 6340, 6344, 6348, 6352, 6356, 6360, 6364, 14624, 14628, 14632, 14636, 7344, 7348, 7352, 7356
    .short 7360, 7364, 7368, 7372, 7376, 7380, 7384, 7388, 7392, 7396, 7400, 7404, 15664, 15668, 15672, 15676
    .short 4288, 4292, 4296, 4300, 4304, 4308, 4312, 4316, 4320, 4324, 4328, 4332, 4336, 4340, 4344, 4348
    .short 12608, 12612, 12616, 12620, 5328, 5332, 5336, 5340, 5344, 5348, 5352, 5356, 5360, 5364, 5368, 5372
    .short 5376, 5380, 5384, 5388, 13648, 13652, 13656, 13660, 6368, 6372, 6376, 6380, 6384, 6388, 6392, 6396
    .short 6400, 6404, 6408, 6412, 6416, 6420, 6424, 6428, 14688, 14692, 14696, 14700, 7408, 7412, 7416, 7420
    .short 7424, 7428, 7432, 7436, 7440, 7444, 7448, 7452, 7456, 7460, 7464, 7468, 15728, 15732, 15736, 15740
    .short 29120, 29124, 29128, 29132, 29136, 29140, 29144, 29148, 29152, 29156, 29160, 29164, 29168, 29172, 29176, 29180
    .short 30160, 30164, 30168, 30172, 12688, 12692, 12696, 12700, 12704, 12708, 12712, 12716, 12720, 12724, 12728, 12732
    .short 20992, 20996, 21000, 21004, 21008, 21012, 21016, 21020, 13728, 13732, 13736, 13740, 13744, 13748, 13752, 13756
    .short 13760, 13764, 13768, 13772, 22032, 22036, 22040, 22044, 22048, 22052, 22056, 22060, 14768, 14772, 14776, 14780
    .short 14784, 14788, 14792, 14796, 14800, 14804, 14808, 14812, 23072, 23076, 23080, 23084, 23088, 23092, 23096, 23100
    .short 15808, 15812, 15816, 15820, 15824, 15828, 15832, 15836, 15840, 15844, 15848, 15852, 24112, 24116, 24120, 24124
    .short 24128, 24132, 24136, 24140, 16656, 16660, 16664, 16668, 16672, 16676, 16680, 16684, 16688, 16692, 16696, 16700
    .short 24960, 24964, 24968, 24972, 24976, 24980, 24984, 24988, 17696, 17700, 17704, 17708, 17712, 17716, 17720, 17724
    .short 17728, 17732, 17736, 17740, 26000, 26004, 26008, 26012, 26016, 26020, 26024, 26028, 18736, 18740, 18744, 18748
    .short 18752, 18756, 18760, 18764, 18768, 18772, 18776, 18780, 27040, 27044, 27048, 27052, 27056, 27060, 27064, 27068
    .short 19776, 19780, 19784, 19788, 19792, 19796, 19800, 19804, 19808, 19812, 19816, 19820, 28080, 28084, 28088, 28092
    .short 28096, 28100, 28104, 28108, 16720, 16724, 16728, 16732, 16736, 16740, 16744, 16748, 16752, 16756, 16760, 16764
    .short 25024, 25028, 25032, 25036, 25040, 25044, 25048, 25052, 17760, 17764, 17768, 17772, 17776, 17780, 17784, 17788
    .short 17792, 17796, 17800, 17804, 26064, 26068, 26072, 26076, 26080, 26084, 26088, 26092, 18800, 18804, 18808, 18812
    .short 18816, 18820, 18824, 18828, 18832, 18836, 18840, 18844, 27104, 27108, 27112, 27116, 27120, 27124, 27128, 27132
    .short 19840, 19844, 19848, 19852, 19856, 19860, 19864, 19868, 19872, 19876, 19880, 19884, 28144, 28148, 28152, 28156
    .short 28160, 28164, 28168, 28172, 16784, 16788, 16792, 16796, 16800, 16804, 16808, 16812, 16816, 16820, 16824, 16828
    .short 25088, 25092, 25096, 25100, 25104, 25108, 25112, 25116, 17824, 17828, 17832, 17836, 17840, 17844, 17848, 17852
    .short 17856, 17860, 17864, 17868, 26128, 26132, 26136, 26140, 26144, 26148, 26152, 26156, 18864, 18868, 18872, 18876
    .short 18880, 18884, 18888, 18892, 18896, 18900, 18904, 18908, 27168, 27172, 27176, 27180, 27184, 27188, 27192, 27196
    .short 19904, 19908, 19912, 19916, 19920, 19924, 19928, 19932, 19936, 19940, 19944, 19948, 28208, 28212, 28216, 28220
    .short 28224, 28228, 28232, 28236, 16848, 16852, 16856, 16860, 16864, 16868, 16872, 16876, 16880, 16884, 16888, 16892
    .short 25152, 25156, 25160, 25164, 25168, 25172, 25176, 25180, 17888, 17892, 17896, 17900, 17904, 17908, 17912, 17916
    .short 17920, 17924, 17928, 17932, 26192, 26196, 26200, 26204, 26208, 26212, 26216, 26220, 18928, 18932, 18936, 18940
    .short 18944, 18948, 18952, 18956, 18960, 18964, 18968, 18972, 27232, 27236, 27240, 27244, 27248, 27252, 27256, 27260
    .short 19968, 19972, 19976, 19980, 19984, 19988, 19992, 19996, 20000, 20004, 20008, 20012, 28272, 28276, 28280, 28284
    .short 28288, 28292, 28296, 28300, 30176, 30180, 30184, 30188, 30192, 30196, 30200, 30204, 30208, 30212, 30216, 30220
    .short 31200, 31204, 31208, 31212, 31216, 31220, 31224, 31228, 384, 388, 392, 396, 400, 404, 408, 412
    .short 416, 420, 424, 428, 432, 436, 440, 444, 8704, 8708, 8712, 8716, 1424, 1428, 1432, 1436
    .short 1440, 1444, 1448, 1452, 1456, 1460, 1464, 1468, 1472, 1476, 1480, 1484, 9744, 9748, 9752, 9756
    .short 2464, 2468, 2472, 2476, 2480, 2484, 2488, 2492, 2496, 2500, 2504, 2508, 2512, 2516, 2520, 2524
    .short 10784, 10788, 10792, 10796, 3504, 3508, 3512, 3516, 3520, 3524, 3528, 3532, 3536, 3540, 3544, 3548
    .short 3552, 3556, 3560, 3564, 11824, 11828, 11832, 11836, 448, 452, 456, 460, 464, 468, 472, 476
    .short 480, 484, 488, 492, 496, 500, 504, 508, 8768, 8772, 8776, 8780, 1488, 1492, 1496, 1500
    .short 1504, 1508, 1512, 1516, 1520, 1524, 1528, 1532, 1536, 1540, 1544, 1548, 9808, 9812, 9816, 9820
    .short 2528, 2532, 2536, 2540, 2544, 2548, 2552, 2556, 2560, 2564, 2568, 2572, 2576, 2580, 2584, 2588
    .short 10848, 10852, 10856, 10860, 3568, 3572, 3576, 3580, 3584, 3588, 3592, 3596, 3600, 3604, 3608, 3612
    .short 3616, 3620, 3624, 3628, 11888, 11892, 11896, 11900, 4416, 4420, 4424, 4428, 4432, 4436, 4440, 4444
    .short 4448, 4452, 4456, 4460, 4464, 4468, 4472, 4476, 12736, 12740, 12744, 12748, 5456, 5460, 5464, 5468
    .short 5472, 5476, 5480, 5484, 5488, 5492, 5496, 5500, 5504, 5508, 5512, 5516, 13776, 13780, 13784, 13788
    .short 6496, 6500, 6504, 6508, 6512, 6516, 6520, 6524, 6528, 6532, 6536, 6540, 6544, 6548, 6552, 6556
    .short 14816, 14820, 14824, 14828, 7536, 7540, 7544, 7548, 7552, 7556, 7560, 7564, 7568, 7572, 7576, 7580
    .short 7584, 7588, 7592, 7596, 15856, 15860, 15864, 15868, 4480, 4484, 4488, 4492, 4496, 4500, 4504, 4508
    .short 4512, 4516, 4520, 4524, 4528, 4532, 4536, 4540, 12800, 12804, 12808, 12812, 5520, 5524, 5528, 5532
    .short 5536, 5540, 5544, 5548, 5552, 5556, 5560, 5564, 5568, 5572, 5576, 5580, 13840, 13844, 13848, 13852
    .short 6560, 6564, 6568, 6572, 6576, 6580, 6584, 6588, 6592, 6596, 6600, 6604, 6608, 6612, 6616, 6620
    .short 14880, 14884, 14888, 14892, 7600, 7604, 7608, 7612, 7616, 7620, 7624, 7628, 7632, 7636, 7640, 7644
    .short 7648, 7652, 7656, 7660, 15920, 15924, 15928, 15932, 4544, 4548, 4552, 4556, 4560, 4564, 4568, 4572
    .short 4576, 4580, 4584, 4588, 4592, 4596, 4600, 4604, 12864, 12868, 12872, 12876, 5584, 5588, 5592, 5596
    .short 5600, 5604, 5608, 5612, 5616, 5620, 5624, 5628, 5632, 5636, 5640, 5644, 13904, 13908, 13912, 13916
    .short 6624, 6628, 6632, 6636, 6640, 6644, 6648, 6652, 6656, 6660, 6664, 6668, 6672, 6676, 6680, 6684
    .short 14944, 14948, 14952, 14956, 7664, 7668, 7672, 7676, 7680, 7684, 7688, 7692, 7696, 7700, 7704, 7708
    .short 7712, 7716, 7720, 7724, 15984, 15988, 15992, 15996, 29376, 29380, 29384, 29388, 29392, 29396, 29400, 29404
    .short 29408, 29412, 29416, 29420, 29424, 29428, 29432, 29436, 30416, 30420, 30424, 30428, 12944, 12948, 12952, 12956
    .short 12960, 12964, 12968, 12972, 12976, 12980, 12984, 12988, 21248, 21252, 21256, 21260, 21264, 21268, 21272, 21276
    .short 13984, 13988, 13992, 13996, 14000, 14004, 14008, 14012, 14016, 14020, 14024, 14028, 22288, 22292, 22296, 22300
    .short 22304, 22308, 22312, 22316, 15024, 15028, 15032, 15036, 15040, 15044, 15048, 15052, 15056, 15060, 15064, 15068
    .short 23328, 23332, 23336, 23340, 23344, 23348, 23352, 23356, 16064, 16068, 16072, 16076, 16080, 16084, 16088, 16092
    .short 16096, 16100, 16104, 16108, 24368, 24372, 24376, 24380, 24384, 24388, 24392, 24396, 16912, 16916, 16920, 16924
    .short 16928, 16932, 16936, 16940, 16944, 16948, 16952, 16956, 25216, 25220, 25224, 25228, 25232, 25236, 25240, 25244
    .short 17952, 17956, 17960, 17964, 17968, 17972, 17976, 17980, 17984, 17988, 17992, 17996, 26256, 26260, 26264, 26268
    .short 26272, 26276, 26280, 26284, 18992, 18996, 19000, 19004, 19008, 19012, 19016, 19020, 19024, 19028, 19032, 19036
    .short 27296, 27300, 27304, 27308, 27312, 27316, 27320, 27324, 20032, 20036, 20040, 20044, 20048, 20052, 20056, 20060
    .short 20064, 20068, 20072, 20076, 28336, 28340, 28344, 28348, 28352, 28356, 28360, 28364, 16976, 16980, 16984, 16988
    .short 16992, 16996, 17000, 17004, 17008, 17012, 17016, 17020, 25280, 25284, 25288, 25292, 25296, 25300, 25304, 25308
    .short 18016, 18020, 18024, 18028, 18032, 18036, 18040, 18044, 18048, 18052, 18056, 18060, 26320, 26324, 26328, 26332
    .short 26336, 26340, 26344, 26348, 19056, 19060, 19064, 19068, 19072, 19076, 19080, 19084, 19088, 19092, 19096, 19100
    .short 27360, 27364, 27368, 27372, 27376, 27380, 27384, 27388, 20096, 20100, 20104, 20108, 20112, 20116, 20120, 20124
    .short 20128, 20132, 20136, 20140, 28400, 28404, 28408, 28412, 28416, 28420, 28424, 28428, 17040, 17044, 17048, 17052
    .short 17056, 17060, 17064, 17068, 17072, 17076, 17080, 17084, 25344, 25348, 25352, 25356, 25360, 25364, 25368, 25372
    .short 18080, 18084, 18088, 18092, 18096, 18100, 18104, 18108, 18112, 18116, 18120, 18124, 26384, 26388, 26392, 26396
    .short 26400, 26404, 26408, 26412, 19120, 19124, 19128, 19132, 19136, 19140, 19144, 19148, 19152, 19156, 19160, 19164
    .short 27424, 27428, 27432, 27436, 27440, 27444, 27448, 27452, 20160, 20164, 20168, 20172, 20176, 20180, 20184, 20188
    .short 20192, 20196, 20200, 20204, 28464, 28468, 28472, 28476, 28480, 28484, 28488, 28492, 17104, 17108, 17112, 17116
    .short 17120, 17124, 17128, 17132, 17136, 17140, 17144, 17148, 25408, 25412, 25416, 25420, 25424, 25428, 25432, 25436
    .short 18144, 18148, 18152, 18156, 18160, 18164, 18168, 18172, 18176, 18180, 18184, 18188, 26448, 26452, 26456, 26460
    .short 26464, 26468, 26472, 26476, 19184, 19188, 19192, 19196, 19200, 19204, 19208, 19212, 19216, 19220, 19224, 19228
    .short 27488, 27492, 27496, 27500, 27504, 27508, 27512, 27516, 20224, 20228, 20232, 20236, 20240, 20244, 20248, 20252
    .short 20256, 20260, 20264, 20268, 28528, 28532, 28536, 28540, 28544, 28548, 28552, 28556, 30432, 30436, 30440, 30444
    .short 30448, 30452, 30456, 30460, 30464, 30468, 30472, 30476, 31456, 31460, 31464, 31468, 31472, 31476, 31480, 31484
    .short 0, 0, 0, 0, 0, 0, 0, 0, 0, 0, 0, 0, 0, 0, 0, 0
    .short 0, 0, 0, 0, 0, 0, 0, 0, 0, 0, 0, 0, 0, 0, 0, 0
    .short 0, 0, 0, 0, 0, 0, 0, 0, 0, 0, 0, 0, 0, 0, 0, 0
    .short 0, 0, 0, 0, 0, 0, 0, 0, 0, 0, 0, 0, 0, 0, 0, 0
    .short 0, 0, 0, 0, 0, 0, 0, 0, 0, 0, 0, 0, 0, 0, 0, 0
    .short 0, 0, 0, 0, 0, 0, 0, 0, 0, 0, 0, 0, 0, 0, 0, 0
    .short 0, 0, 0, 0, 0, 0, 0, 0, 0, 0, 0, 0, 0, 0, 0, 0
L_code_end:
.section .rodata,"a"
.p2align 6
.amdhsa_kernel gated_mix__ssm_conv_s4__linear_attn_block__prompt_kernel
  .amdhsa_next_free_vgpr 256
  .amdhsa_next_free_sgpr 100
  .amdhsa_accum_offset 256
  .amdhsa_group_segment_fixed_size 0
  .amdhsa_kernarg_size 128
  .amdhsa_user_sgpr_count 2
  .amdhsa_user_sgpr_kernarg_segment_ptr 1
  .amdhsa_system_sgpr_workgroup_id_x 1
.end_amdhsa_kernel
```
